```python
import torch

def _softmax(x, axis=-1):
    return torch.softmax(x, dim=axis)
def _gelu(x):
    return torch.nn.functional.gelu(x, approximate="tanh")
def _silu(x):
    return torch.nn.functional.silu(x)
def _sigmoid(x):
    return torch.sigmoid(x)
def _layernorm(x, axis=-1, eps=1e-5):
    m = x.mean(dim=axis, keepdim=True)
    v = x.var(dim=axis, keepdim=True, unbiased=False)
    return (x - m) / torch.sqrt(v + eps)
def _scatter_add(tgt, idx, src, axis=0):
    return tgt.clone().index_add_(axis, idx, src)
def _segment_sum(src, seg, n):
    out = torch.zeros((n,) + src.shape[1:], dtype=src.dtype)
    return out.index_add_(0, seg, src)
def _pad(x, pw):
    flat = tuple(v for pair in reversed(pw) for v in pair)
    return torch.nn.functional.pad(x, flat)

kernel_name = 'standalone__softmax_full_bidir__sampling'

def setup_inputs():

    _w = (lambda a: (lambda t: t.to(torch.bfloat16) if t.is_floating_point() else t)(torch.as_tensor(a)))
    B, H, Sq, Skv, Dh = 8, 32, 1, 4096, 192
    return {
        "q": _w((lambda *s: torch.randn(*s, dtype=torch.bfloat16) * 0.8)(B, H, Sq, Dh)),
        "k": _w((lambda *s: torch.randn(*s, dtype=torch.bfloat16) * 0.8)(B, H, Skv, Dh)),
        "v": _w((lambda *s: torch.randn(*s, dtype=torch.bfloat16) * 0.05)(B, H, Skv, Dh)),
    }

def reference(q, k, v):
    scale = q.shape[-1] ** -0.5
    scores = torch.einsum('bhqd,bhkd->bhqk', q, k) * scale
    attn = _softmax(scores, axis=-1)
    return torch.einsum('bhqk,bhkd->bhqd', attn, v)
```

```asm
; @launch grid=(256,1,1) block=(320,1,1) lds=90000
.amdgcn_target "amdgcn-amd-amdhsa--gfx950"
.text
.globl standalone__softmax_full_bidir__sampling_kernel
.p2align 8
.type standalone__softmax_full_bidir__sampling_kernel,@function
standalone__softmax_full_bidir__sampling_kernel:
  s_cmp_ge_u32 s2, 256
  s_cbranch_scc1 L_end
  s_load_dwordx4 s[24:27], s[0:1], 0
  s_load_dwordx4 s[28:31], s[0:1], 16
  s_load_dwordx2 s[50:51], s[0:1], 40
  s_load_dwordx2 s[62:63], s[0:1], 32
  s_getreg_b32 s57, hwreg(HW_REG_XCC_ID)
  v_lshrrev_b32 v2, 6, v0
  v_and_b32 v3, 63, v0
  v_readfirstlane_b32 s20, v2
  v_lshrrev_b32 v4, 3, v3
  v_and_b32 v5, 7, v3
  v_lshlrev_b32 v2, 5, v5
  v_lshl_add_u32 v162, v4, 2, v2
  v_lshlrev_b32 v160, 2, v3
  v_lshlrev_b32 v161, 5, v4
  v_mul_u32_u24 v4, 384, v4
  v_lshlrev_b32 v5, 4, v5
  v_add_u32 v1, v4, v5
  s_mul_i32 s21, s2, 1572864
  s_mul_i32 s22, s2, 384
  s_mul_i32 s23, s20, 4096
  v_add_u32 v160, s23, v160
  v_add_u32 v161, s23, v161
  s_mul_i32 s23, s20, 784
  v_add_u32 v162, s23, v162
  s_mov_b32 s6, 1572864
  s_mov_b32 s7, 0x00020000
  s_mov_b32 s14, 384
  s_mov_b32 s15, 0x00020000
  s_lshr_b32 s37, s2, 3
  s_mul_i32 s32, s37, 37
  s_and_b32 s37, s2, 7
  s_mul_i32 s37, s37, 37
  s_add_u32 s32, s32, s37
  s_waitcnt lgkmcnt(0)
  s_add_u32 s48, s50, 2097152
  s_addc_u32 s49, s51, 0
  s_and_b32 s57, s57, 15
  s_mul_i32 s57, s57, 4096
  s_add_u32 s57, s57, 1048576
  s_add_u32 s50, s50, s57
  s_addc_u32 s51, s51, 0
  s_cmp_eq_u32 s20, 4
  s_cbranch_scc1 L_help
  s_add_u32 s12, s24, s22
  s_addc_u32 s13, s25, 0
  s_and_b32 s13, s13, 0xffff
  s_add_u32 s4, s26, s21
  s_addc_u32 s5, s27, 0
  s_and_b32 s5, s5, 0xffff
  buffer_load_dwordx4 v[28:31], v5, s[12:15], 0 offen
  buffer_load_dwordx4 v[32:35], v5, s[12:15], 0 offen offset:128
  buffer_load_dwordx4 v[36:39], v5, s[12:15], 0 offen offset:256
  s_cmp_lt_u32 s2, 8
  s_cselect_b32 s53, 1, 0
  s_cmp_eq_u32 s20, 0
  s_cselect_b32 s53, s53, 0
  s_mov_b32 s55, 0
  s_mov_b32 s56, -64
  v_mov_b32 v11, 0
  v_mov_b32 v165, 0
  s_add_u32 s32, s32, s20
  s_and_b32 s32, s32, 127
  s_mul_i32 s16, s32, 12288
  s_add_u32 s17, s16, 49152
  s_sub_u32 s32, s17, 1572864
  s_cmp_ge_u32 s17, 1572864
  s_cselect_b32 s17, s32, s17
  s_add_u32 s8, s28, s21
  s_addc_u32 s9, s29, 0
  s_and_b32 s9, s9, 0xffff
  buffer_load_dwordx4 v[64:67], v1, s[4:7], s16 offen nt
  buffer_load_dwordx4 v[68:71], v1, s[4:7], s16 offen offset:128 nt
  buffer_load_dwordx4 v[72:75], v1, s[4:7], s16 offen offset:256 nt
  s_add_u32 s21, s16, 0xc00
  buffer_load_dwordx4 v[76:79], v1, s[4:7], s21 offen nt
  buffer_load_dwordx4 v[80:83], v1, s[4:7], s21 offen offset:128 nt
  buffer_load_dwordx4 v[84:87], v1, s[4:7], s21 offen offset:256 nt
  s_add_u32 s21, s16, 0x1800
  buffer_load_dwordx4 v[88:91], v1, s[4:7], s21 offen nt
  buffer_load_dwordx4 v[92:95], v1, s[4:7], s21 offen offset:128 nt
  buffer_load_dwordx4 v[96:99], v1, s[4:7], s21 offen offset:256 nt
  s_add_u32 s21, s16, 0x2400
  buffer_load_dwordx4 v[100:103], v1, s[4:7], s21 offen nt
  buffer_load_dwordx4 v[104:107], v1, s[4:7], s21 offen offset:128 nt
  buffer_load_dwordx4 v[108:111], v1, s[4:7], s21 offen offset:256 nt
  buffer_load_dwordx4 v[112:115], v1, s[4:7], s17 offen nt
  buffer_load_dwordx4 v[116:119], v1, s[4:7], s17 offen offset:128 nt
  buffer_load_dwordx4 v[120:123], v1, s[4:7], s17 offen offset:256 nt
  s_add_u32 s21, s17, 0xc00
  buffer_load_dwordx4 v[124:127], v1, s[4:7], s21 offen nt
  buffer_load_dwordx4 v[128:131], v1, s[4:7], s21 offen offset:128 nt
  buffer_load_dwordx4 v[132:135], v1, s[4:7], s21 offen offset:256 nt
  s_add_u32 s21, s17, 0x1800
  buffer_load_dwordx4 v[136:139], v1, s[4:7], s21 offen nt
  buffer_load_dwordx4 v[140:143], v1, s[4:7], s21 offen offset:128 nt
  buffer_load_dwordx4 v[144:147], v1, s[4:7], s21 offen offset:256 nt
  s_add_u32 s21, s17, 0x2400
  buffer_load_dwordx4 v[148:151], v1, s[4:7], s21 offen nt
  buffer_load_dwordx4 v[152:155], v1, s[4:7], s21 offen offset:128 nt
  buffer_load_dwordx4 v[156:159], v1, s[4:7], s21 offen offset:256 nt
  s_add_u32 s16, s16, 98304
  s_sub_u32 s32, s16, 1572864
  s_cmp_ge_u32 s16, 1572864
  s_cselect_b32 s16, s32, s16
  s_add_u32 s17, s17, 98304
  s_sub_u32 s32, s17, 1572864
  s_cmp_ge_u32 s17, 1572864
  s_cselect_b32 s17, s32, s17
  s_barrier
  s_mov_b32 s19, 0x3dd53b95
  s_mov_b32 s34, 0xaaaaaaaa
  s_mov_b32 s35, 0xaaaaaaaa
  s_mov_b32 s36, 0xcccccccc
  s_mov_b32 s37, 0xcccccccc
  v_mov_b32 v6, 0xff800000
  v_mov_b32 v40, 0
  v_mov_b32 v41, 0
  v_mov_b32 v42, 0
  v_mov_b32 v43, 0
  v_mov_b32 v44, 0
  v_mov_b32 v45, 0
  v_mov_b32 v46, 0
  v_mov_b32 v47, 0
  v_mov_b32 v48, 0
  v_mov_b32 v49, 0
  v_mov_b32 v50, 0
  v_mov_b32 v51, 0
  v_mov_b32 v52, 0
  v_mov_b32 v53, 0
  v_mov_b32 v54, 0
  v_mov_b32 v55, 0
  v_mov_b32 v56, 0
  v_mov_b32 v57, 0
  v_mov_b32 v58, 0
  v_mov_b32 v59, 0
  v_mov_b32 v60, 0
  v_mov_b32 v61, 0
  v_mov_b32 v62, 0
  v_mov_b32 v63, 0
  s_mov_b32 s18, 16
.p2align 3
L_kd:
  s_mov_b32 s61, 0x0
  s_cmp_gt_i32 s56, 24
  s_cselect_b32 s61, 0xaa55, s61
  s_cmp_gt_i32 s56, 26
  s_cselect_b32 s61, 0x887700, s61
  s_cmp_gt_i32 s56, 29
  s_cselect_b32 s61, 0xaa5500, s61
  s_waitcnt vmcnt(21)
  v_dot2_f32_bf16 v12, v64, v28, 0
  v_dot2_f32_bf16 v12, v65, v29, v12
  v_dot2_f32_bf16 v12, v66, v30, v12
  v_dot2_f32_bf16 v12, v67, v31, v12
  v_dot2_f32_bf16 v12, v68, v32, v12
  v_dot2_f32_bf16 v12, v69, v33, v12
  v_dot2_f32_bf16 v12, v70, v34, v12
  v_dot2_f32_bf16 v12, v71, v35, v12
  v_dot2_f32_bf16 v12, v72, v36, v12
  v_dot2_f32_bf16 v12, v73, v37, v12
  v_dot2_f32_bf16 v12, v74, v38, v12
  v_dot2_f32_bf16 v12, v75, v39, v12
  s_waitcnt vmcnt(6)
  s_bitcmp1_b32 s61, 0
  s_cbranch_scc0 L_w1
  s_waitcnt vmcnt(5)
L_w1:
  s_bitcmp1_b32 s61, 8
  s_cbranch_scc0 L_w2
  s_waitcnt vmcnt(4)
L_w2:
  buffer_load_dwordx4 v[64:67], v1, s[4:7], s16 offen nt
  buffer_load_dwordx4 v[68:71], v1, s[4:7], s16 offen offset:128 nt
  buffer_load_dwordx4 v[72:75], v1, s[4:7], s16 offen offset:256 nt
  s_waitcnt vmcnt(21)
  v_dot2_f32_bf16 v13, v76, v28, 0
  v_dot2_f32_bf16 v13, v77, v29, v13
  v_dot2_f32_bf16 v13, v78, v30, v13
  v_dot2_f32_bf16 v13, v79, v31, v13
  v_dot2_f32_bf16 v13, v80, v32, v13
  v_dot2_f32_bf16 v13, v81, v33, v13
  v_dot2_f32_bf16 v13, v82, v34, v13
  v_dot2_f32_bf16 v13, v83, v35, v13
  v_dot2_f32_bf16 v13, v84, v36, v13
  v_dot2_f32_bf16 v13, v85, v37, v13
  v_dot2_f32_bf16 v13, v86, v38, v13
  v_dot2_f32_bf16 v13, v87, v39, v13
  s_waitcnt vmcnt(6)
  s_bitcmp1_b32 s61, 9
  s_cbranch_scc0 L_w3
  s_waitcnt vmcnt(4)
L_w3:
  s_bitcmp1_b32 s61, 17
  s_cbranch_scc0 L_w4
  s_waitcnt vmcnt(3)
L_w4:
  s_add_u32 s21, s16, 0xc00
  buffer_load_dwordx4 v[76:79], v1, s[4:7], s21 offen nt
  buffer_load_dwordx4 v[80:83], v1, s[4:7], s21 offen offset:128 nt
  buffer_load_dwordx4 v[84:87], v1, s[4:7], s21 offen offset:256 nt
  s_waitcnt vmcnt(21)
  v_dot2_f32_bf16 v14, v88, v28, 0
  v_dot2_f32_bf16 v14, v89, v29, v14
  v_dot2_f32_bf16 v14, v90, v30, v14
  v_dot2_f32_bf16 v14, v91, v31, v14
  v_dot2_f32_bf16 v14, v92, v32, v14
  v_dot2_f32_bf16 v14, v93, v33, v14
  v_dot2_f32_bf16 v14, v94, v34, v14
  v_dot2_f32_bf16 v14, v95, v35, v14
  v_dot2_f32_bf16 v14, v96, v36, v14
  v_dot2_f32_bf16 v14, v97, v37, v14
  v_dot2_f32_bf16 v14, v98, v38, v14
  v_dot2_f32_bf16 v14, v99, v39, v14
  s_waitcnt vmcnt(6)
  s_bitcmp1_b32 s61, 2
  s_cbranch_scc0 L_w5
  s_waitcnt vmcnt(5)
L_w5:
  s_bitcmp1_b32 s61, 10
  s_cbranch_scc0 L_w6
  s_waitcnt vmcnt(4)
L_w6:
  s_add_u32 s21, s16, 0x1800
  buffer_load_dwordx4 v[88:91], v1, s[4:7], s21 offen nt
  buffer_load_dwordx4 v[92:95], v1, s[4:7], s21 offen offset:128 nt
  buffer_load_dwordx4 v[96:99], v1, s[4:7], s21 offen offset:256 nt
  s_waitcnt vmcnt(21)
  v_dot2_f32_bf16 v15, v100, v28, 0
  v_dot2_f32_bf16 v15, v101, v29, v15
  v_dot2_f32_bf16 v15, v102, v30, v15
  v_dot2_f32_bf16 v15, v103, v31, v15
  v_dot2_f32_bf16 v15, v104, v32, v15
  v_dot2_f32_bf16 v15, v105, v33, v15
  v_dot2_f32_bf16 v15, v106, v34, v15
  v_dot2_f32_bf16 v15, v107, v35, v15
  v_dot2_f32_bf16 v15, v108, v36, v15
  v_dot2_f32_bf16 v15, v109, v37, v15
  v_dot2_f32_bf16 v15, v110, v38, v15
  v_dot2_f32_bf16 v15, v111, v39, v15
  s_waitcnt vmcnt(6)
  s_bitcmp1_b32 s61, 11
  s_cbranch_scc0 L_w7
  s_waitcnt vmcnt(4)
L_w7:
  s_bitcmp1_b32 s61, 19
  s_cbranch_scc0 L_w8
  s_waitcnt vmcnt(3)
L_w8:
  s_add_u32 s21, s16, 0x2400
  buffer_load_dwordx4 v[100:103], v1, s[4:7], s21 offen nt
  buffer_load_dwordx4 v[104:107], v1, s[4:7], s21 offen offset:128 nt
  buffer_load_dwordx4 v[108:111], v1, s[4:7], s21 offen offset:256 nt
  s_waitcnt vmcnt(21)
  v_dot2_f32_bf16 v16, v112, v28, 0
  v_dot2_f32_bf16 v16, v113, v29, v16
  v_dot2_f32_bf16 v16, v114, v30, v16
  v_dot2_f32_bf16 v16, v115, v31, v16
  v_dot2_f32_bf16 v16, v116, v32, v16
  v_dot2_f32_bf16 v16, v117, v33, v16
  v_dot2_f32_bf16 v16, v118, v34, v16
  v_dot2_f32_bf16 v16, v119, v35, v16
  v_dot2_f32_bf16 v16, v120, v36, v16
  v_dot2_f32_bf16 v16, v121, v37, v16
  v_dot2_f32_bf16 v16, v122, v38, v16
  v_dot2_f32_bf16 v16, v123, v39, v16
  s_waitcnt vmcnt(6)
  s_bitcmp1_b32 s61, 4
  s_cbranch_scc0 L_w9
  s_waitcnt vmcnt(5)
L_w9:
  s_bitcmp1_b32 s61, 12
  s_cbranch_scc0 L_w10
  s_waitcnt vmcnt(4)
L_w10:
  buffer_load_dwordx4 v[112:115], v1, s[4:7], s17 offen nt
  buffer_load_dwordx4 v[116:119], v1, s[4:7], s17 offen offset:128 nt
  buffer_load_dwordx4 v[120:123], v1, s[4:7], s17 offen offset:256 nt
  global_load_dword v165, v11, s[50:51] sc0
  s_waitcnt vmcnt(21)
  v_dot2_f32_bf16 v17, v124, v28, 0
  v_dot2_f32_bf16 v17, v125, v29, v17
  v_dot2_f32_bf16 v17, v126, v30, v17
  v_dot2_f32_bf16 v17, v127, v31, v17
  v_dot2_f32_bf16 v17, v128, v32, v17
  v_dot2_f32_bf16 v17, v129, v33, v17
  v_dot2_f32_bf16 v17, v130, v34, v17
  v_dot2_f32_bf16 v17, v131, v35, v17
  v_dot2_f32_bf16 v17, v132, v36, v17
  v_dot2_f32_bf16 v17, v133, v37, v17
  v_dot2_f32_bf16 v17, v134, v38, v17
  v_dot2_f32_bf16 v17, v135, v39, v17
  s_waitcnt vmcnt(6)
  s_bitcmp1_b32 s61, 13
  s_cbranch_scc0 L_w11
  s_waitcnt vmcnt(4)
L_w11:
  s_bitcmp1_b32 s61, 21
  s_cbranch_scc0 L_w12
  s_waitcnt vmcnt(3)
L_w12:
  s_add_u32 s21, s17, 0xc00
  buffer_load_dwordx4 v[124:127], v1, s[4:7], s21 offen nt
  buffer_load_dwordx4 v[128:131], v1, s[4:7], s21 offen offset:128 nt
  buffer_load_dwordx4 v[132:135], v1, s[4:7], s21 offen offset:256 nt
  s_waitcnt vmcnt(21)
  v_dot2_f32_bf16 v18, v136, v28, 0
  v_dot2_f32_bf16 v18, v137, v29, v18
  v_dot2_f32_bf16 v18, v138, v30, v18
  v_dot2_f32_bf16 v18, v139, v31, v18
  v_dot2_f32_bf16 v18, v140, v32, v18
  v_dot2_f32_bf16 v18, v141, v33, v18
  v_dot2_f32_bf16 v18, v142, v34, v18
  v_dot2_f32_bf16 v18, v143, v35, v18
  v_dot2_f32_bf16 v18, v144, v36, v18
  v_dot2_f32_bf16 v18, v145, v37, v18
  v_dot2_f32_bf16 v18, v146, v38, v18
  v_dot2_f32_bf16 v18, v147, v39, v18
  s_waitcnt vmcnt(6)
  s_bitcmp1_b32 s61, 6
  s_cbranch_scc0 L_w13
  s_waitcnt vmcnt(5)
L_w13:
  s_bitcmp1_b32 s61, 14
  s_cbranch_scc0 L_w14
  s_waitcnt vmcnt(4)
L_w14:
  s_add_u32 s21, s17, 0x1800
  buffer_load_dwordx4 v[136:139], v1, s[4:7], s21 offen nt
  buffer_load_dwordx4 v[140:143], v1, s[4:7], s21 offen offset:128 nt
  buffer_load_dwordx4 v[144:147], v1, s[4:7], s21 offen offset:256 nt
  s_waitcnt vmcnt(21)
  v_dot2_f32_bf16 v19, v148, v28, 0
  v_dot2_f32_bf16 v19, v149, v29, v19
  v_dot2_f32_bf16 v19, v150, v30, v19
  v_dot2_f32_bf16 v19, v151, v31, v19
  v_dot2_f32_bf16 v19, v152, v32, v19
  v_dot2_f32_bf16 v19, v153, v33, v19
  v_dot2_f32_bf16 v19, v154, v34, v19
  v_dot2_f32_bf16 v19, v155, v35, v19
  v_dot2_f32_bf16 v19, v156, v36, v19
  v_dot2_f32_bf16 v19, v157, v37, v19
  v_dot2_f32_bf16 v19, v158, v38, v19
  v_dot2_f32_bf16 v19, v159, v39, v19
  s_waitcnt vmcnt(6)
  s_bitcmp1_b32 s61, 15
  s_cbranch_scc0 L_w15
  s_waitcnt vmcnt(4)
L_w15:
  s_bitcmp1_b32 s61, 23
  s_cbranch_scc0 L_w16
  s_waitcnt vmcnt(3)
L_w16:
  s_add_u32 s21, s17, 0x2400
  buffer_load_dwordx4 v[148:151], v1, s[4:7], s21 offen nt
  buffer_load_dwordx4 v[152:155], v1, s[4:7], s21 offen offset:128 nt
  buffer_load_dwordx4 v[156:159], v1, s[4:7], s21 offen offset:256 nt
  s_waitcnt vmcnt(9)
  v_readfirstlane_b32 s52, v165
  s_add_u32 s55, s55, 8
  s_sub_u32 s56, s55, s52
  s_add_u32 s57, s56, 8
  s_cmp_lt_u32 s57, 80
  s_cselect_b32 s57, s52, 0
  s_cmp_gt_u32 s55, 8
  s_cselect_b32 s57, s57, 0
  s_cmp_eq_u32 s57, 0
  s_cselect_b32 s56, -64, s56
  s_cmp_eq_u32 s53, 0
  s_cbranch_scc1 L_f8
  s_lshr_b32 s57, s55, 3
  v_mov_b32 v164, s57
  ds_write_b32 v11, v164 offset:20000
L_f8:
  v_add_f32_dpp v12, v12, v12 row_half_mirror row_mask:0xf bank_mask:0x5
  v_add_f32_dpp v13, v13, v13 row_half_mirror row_mask:0xf bank_mask:0x5
  v_add_f32_dpp v14, v14, v14 row_half_mirror row_mask:0xf bank_mask:0x5
  v_add_f32_dpp v15, v15, v15 row_half_mirror row_mask:0xf bank_mask:0x5
  v_add_f32_dpp v12, v16, v16 row_half_mirror row_mask:0xf bank_mask:0xa
  v_add_f32_dpp v13, v17, v17 row_half_mirror row_mask:0xf bank_mask:0xa
  v_add_f32_dpp v14, v18, v18 row_half_mirror row_mask:0xf bank_mask:0xa
  v_add_f32_dpp v15, v19, v19 row_half_mirror row_mask:0xf bank_mask:0xa
  v_add_f32_dpp v12, v12, v12 quad_perm:[1,0,3,2] row_mask:0xf bank_mask:0xf
  v_add_f32_dpp v13, v13, v13 quad_perm:[1,0,3,2] row_mask:0xf bank_mask:0xf
  v_add_f32_dpp v14, v14, v14 quad_perm:[1,0,3,2] row_mask:0xf bank_mask:0xf
  v_add_f32_dpp v15, v15, v15 quad_perm:[1,0,3,2] row_mask:0xf bank_mask:0xf
  v_add_f32_dpp v12, v12, v12 quad_perm:[2,3,0,1] row_mask:0xf bank_mask:0xf
  v_add_f32_dpp v13, v13, v13 quad_perm:[2,3,0,1] row_mask:0xf bank_mask:0xf
  v_add_f32_dpp v14, v14, v14 quad_perm:[2,3,0,1] row_mask:0xf bank_mask:0xf
  v_add_f32_dpp v15, v15, v15 quad_perm:[2,3,0,1] row_mask:0xf bank_mask:0xf
  v_cndmask_b32 v2, v12, v13, s[34:35]
  v_cndmask_b32 v3, v14, v15, s[34:35]
  v_cndmask_b32 v2, v2, v3, s[36:37]
  v_max_f32 v6, v6, v2
  ds_write_b32 v160, v2
  v_add_u32 v160, 0x100, v160
  s_add_u32 s16, s16, 98304
  s_sub_u32 s32, s16, 1572864
  s_cmp_ge_u32 s16, 1572864
  s_cselect_b32 s16, s32, s16
  s_add_u32 s17, s17, 98304
  s_sub_u32 s32, s17, 1572864
  s_cmp_ge_u32 s17, 1572864
  s_cselect_b32 s17, s32, s17
  s_sub_u32 s18, s18, 1
  s_cmp_eq_u32 s18, 1
  s_cselect_b32 s4, s8, s4
  s_cselect_b32 s5, s9, s5
  s_cmp_lg_u32 s18, 0
  s_cbranch_scc1 L_kd
  ds_read_b128 v[12:15], v161
  ds_read_b128 v[16:19], v161 offset:16
  v_add_u32 v161, 0x100, v161
  v_max_f32_dpp v6, v6, v6 quad_perm:[1,0,3,2] row_mask:0xf bank_mask:0xf
  s_nop 1
  v_max_f32_dpp v6, v6, v6 quad_perm:[2,3,0,1] row_mask:0xf bank_mask:0xf
  s_nop 1
  v_max_f32_dpp v6, v6, v6 row_half_mirror row_mask:0xf bank_mask:0xf
  s_nop 1
  v_max_f32_dpp v6, v6, v6 row_ror:8 row_mask:0xf bank_mask:0xf
  s_nop 1
  v_mov_b32 v3, v6
  s_nop 1
  v_permlane16_swap_b32 v6, v3
  s_nop 0
  v_max_f32 v6, v6, v3
  v_mov_b32 v3, v6
  s_nop 1
  v_permlane32_swap_b32 v6, v3
  s_nop 0
  v_max_f32 v6, v6, v3
  v_mul_f32 v9, s19, v6
  s_waitcnt lgkmcnt(0)
  v_fma_f32 v20, v12, s19, -v9
  v_fma_f32 v21, v13, s19, -v9
  v_fma_f32 v22, v14, s19, -v9
  v_fma_f32 v23, v15, s19, -v9
  v_fma_f32 v24, v16, s19, -v9
  v_fma_f32 v25, v17, s19, -v9
  v_fma_f32 v26, v18, s19, -v9
  v_fma_f32 v27, v19, s19, -v9
  v_exp_f32 v20, v20
  v_exp_f32 v21, v21
  v_exp_f32 v22, v22
  v_exp_f32 v23, v23
  v_exp_f32 v24, v24
  v_exp_f32 v25, v25
  v_exp_f32 v26, v26
  v_exp_f32 v27, v27
  s_nop 0
  v_add_f32 v7, v20, v21
  v_add_f32 v7, v7, v22
  v_add_f32 v7, v7, v23
  v_add_f32 v7, v7, v24
  v_add_f32 v7, v7, v25
  v_add_f32 v7, v7, v26
  v_add_f32 v7, v7, v27
  s_mov_b32 s18, 14
.p2align 3
L_vd:
  s_mov_b32 s61, 0x0
  s_cmp_gt_i32 s56, 24
  s_cselect_b32 s61, 0xaa55, s61
  s_cmp_gt_i32 s56, 26
  s_cselect_b32 s61, 0x887700, s61
  s_cmp_gt_i32 s56, 29
  s_cselect_b32 s61, 0xaa5500, s61
  ds_read_b128 v[12:15], v161
  ds_read_b128 v[16:19], v161 offset:16
  v_add_u32 v161, 0x100, v161
  s_waitcnt vmcnt(21)
  v_lshlrev_b32 v2, 16, v64
  v_and_b32 v3, 0xffff0000, v64
  v_pk_fma_f32 v[40:41], v[2:3], v[20:21], v[40:41] op_sel_hi:[1,0,1]
  v_lshlrev_b32 v4, 16, v65
  v_and_b32 v5, 0xffff0000, v65
  v_pk_fma_f32 v[42:43], v[4:5], v[20:21], v[42:43] op_sel_hi:[1,0,1]
  v_lshlrev_b32 v2, 16, v66
  v_and_b32 v3, 0xffff0000, v66
  v_pk_fma_f32 v[44:45], v[2:3], v[20:21], v[44:45] op_sel_hi:[1,0,1]
  v_lshlrev_b32 v4, 16, v67
  v_and_b32 v5, 0xffff0000, v67
  v_pk_fma_f32 v[46:47], v[4:5], v[20:21], v[46:47] op_sel_hi:[1,0,1]
  v_lshlrev_b32 v2, 16, v68
  v_and_b32 v3, 0xffff0000, v68
  v_pk_fma_f32 v[48:49], v[2:3], v[20:21], v[48:49] op_sel_hi:[1,0,1]
  v_lshlrev_b32 v4, 16, v69
  v_and_b32 v5, 0xffff0000, v69
  v_pk_fma_f32 v[50:51], v[4:5], v[20:21], v[50:51] op_sel_hi:[1,0,1]
  v_lshlrev_b32 v2, 16, v70
  v_and_b32 v3, 0xffff0000, v70
  v_pk_fma_f32 v[52:53], v[2:3], v[20:21], v[52:53] op_sel_hi:[1,0,1]
  v_lshlrev_b32 v4, 16, v71
  v_and_b32 v5, 0xffff0000, v71
  v_pk_fma_f32 v[54:55], v[4:5], v[20:21], v[54:55] op_sel_hi:[1,0,1]
  v_lshlrev_b32 v2, 16, v72
  v_and_b32 v3, 0xffff0000, v72
  v_pk_fma_f32 v[56:57], v[2:3], v[20:21], v[56:57] op_sel_hi:[1,0,1]
  v_lshlrev_b32 v4, 16, v73
  v_and_b32 v5, 0xffff0000, v73
  v_pk_fma_f32 v[58:59], v[4:5], v[20:21], v[58:59] op_sel_hi:[1,0,1]
  v_lshlrev_b32 v2, 16, v74
  v_and_b32 v3, 0xffff0000, v74
  v_pk_fma_f32 v[60:61], v[2:3], v[20:21], v[60:61] op_sel_hi:[1,0,1]
  v_lshlrev_b32 v4, 16, v75
  v_and_b32 v5, 0xffff0000, v75
  v_pk_fma_f32 v[62:63], v[4:5], v[20:21], v[62:63] op_sel_hi:[1,0,1]
  s_waitcnt lgkmcnt(0)
  v_fma_f32 v20, v12, s19, -v9
  v_exp_f32 v20, v20
  s_waitcnt vmcnt(5)
  s_bitcmp1_b32 s61, 0
  s_cbranch_scc0 L_w17
  s_waitcnt vmcnt(4)
L_w17:
  s_bitcmp1_b32 s61, 8
  s_cbranch_scc0 L_w18
  s_waitcnt vmcnt(3)
L_w18:
  buffer_load_dwordx4 v[64:67], v1, s[4:7], s16 offen nt
  buffer_load_dwordx4 v[68:71], v1, s[4:7], s16 offen offset:128 nt
  buffer_load_dwordx4 v[72:75], v1, s[4:7], s16 offen offset:256 nt
  v_add_f32 v7, v7, v20
  s_waitcnt vmcnt(21)
  v_lshlrev_b32 v2, 16, v76
  v_and_b32 v3, 0xffff0000, v76
  v_pk_fma_f32 v[40:41], v[2:3], v[20:21], v[40:41] op_sel:[0,1,0] op_sel_hi:[1,1,1]
  v_lshlrev_b32 v4, 16, v77
  v_and_b32 v5, 0xffff0000, v77
  v_pk_fma_f32 v[42:43], v[4:5], v[20:21], v[42:43] op_sel:[0,1,0] op_sel_hi:[1,1,1]
  v_lshlrev_b32 v2, 16, v78
  v_and_b32 v3, 0xffff0000, v78
  v_pk_fma_f32 v[44:45], v[2:3], v[20:21], v[44:45] op_sel:[0,1,0] op_sel_hi:[1,1,1]
  v_lshlrev_b32 v4, 16, v79
  v_and_b32 v5, 0xffff0000, v79
  v_pk_fma_f32 v[46:47], v[4:5], v[20:21], v[46:47] op_sel:[0,1,0] op_sel_hi:[1,1,1]
  v_lshlrev_b32 v2, 16, v80
  v_and_b32 v3, 0xffff0000, v80
  v_pk_fma_f32 v[48:49], v[2:3], v[20:21], v[48:49] op_sel:[0,1,0] op_sel_hi:[1,1,1]
  v_lshlrev_b32 v4, 16, v81
  v_and_b32 v5, 0xffff0000, v81
  v_pk_fma_f32 v[50:51], v[4:5], v[20:21], v[50:51] op_sel:[0,1,0] op_sel_hi:[1,1,1]
  v_lshlrev_b32 v2, 16, v82
  v_and_b32 v3, 0xffff0000, v82
  v_pk_fma_f32 v[52:53], v[2:3], v[20:21], v[52:53] op_sel:[0,1,0] op_sel_hi:[1,1,1]
  v_lshlrev_b32 v4, 16, v83
  v_and_b32 v5, 0xffff0000, v83
  v_pk_fma_f32 v[54:55], v[4:5], v[20:21], v[54:55] op_sel:[0,1,0] op_sel_hi:[1,1,1]
  v_lshlrev_b32 v2, 16, v84
  v_and_b32 v3, 0xffff0000, v84
  v_pk_fma_f32 v[56:57], v[2:3], v[20:21], v[56:57] op_sel:[0,1,0] op_sel_hi:[1,1,1]
  v_lshlrev_b32 v4, 16, v85
  v_and_b32 v5, 0xffff0000, v85
  v_pk_fma_f32 v[58:59], v[4:5], v[20:21], v[58:59] op_sel:[0,1,0] op_sel_hi:[1,1,1]
  v_lshlrev_b32 v2, 16, v86
  v_and_b32 v3, 0xffff0000, v86
  v_pk_fma_f32 v[60:61], v[2:3], v[20:21], v[60:61] op_sel:[0,1,0] op_sel_hi:[1,1,1]
  v_lshlrev_b32 v4, 16, v87
  v_and_b32 v5, 0xffff0000, v87
  v_pk_fma_f32 v[62:63], v[4:5], v[20:21], v[62:63] op_sel:[0,1,0] op_sel_hi:[1,1,1]
  v_fma_f32 v21, v13, s19, -v9
  v_exp_f32 v21, v21
  s_waitcnt vmcnt(5)
  s_bitcmp1_b32 s61, 9
  s_cbranch_scc0 L_w19
  s_waitcnt vmcnt(3)
L_w19:
  s_bitcmp1_b32 s61, 17
  s_cbranch_scc0 L_w20
  s_waitcnt vmcnt(2)
L_w20:
  s_add_u32 s21, s16, 0xc00
  buffer_load_dwordx4 v[76:79], v1, s[4:7], s21 offen nt
  buffer_load_dwordx4 v[80:83], v1, s[4:7], s21 offen offset:128 nt
  buffer_load_dwordx4 v[84:87], v1, s[4:7], s21 offen offset:256 nt
  v_add_f32 v7, v7, v21
  s_waitcnt vmcnt(21)
  v_lshlrev_b32 v2, 16, v88
  v_and_b32 v3, 0xffff0000, v88
  v_pk_fma_f32 v[40:41], v[2:3], v[22:23], v[40:41] op_sel_hi:[1,0,1]
  v_lshlrev_b32 v4, 16, v89
  v_and_b32 v5, 0xffff0000, v89
  v_pk_fma_f32 v[42:43], v[4:5], v[22:23], v[42:43] op_sel_hi:[1,0,1]
  v_lshlrev_b32 v2, 16, v90
  v_and_b32 v3, 0xffff0000, v90
  v_pk_fma_f32 v[44:45], v[2:3], v[22:23], v[44:45] op_sel_hi:[1,0,1]
  v_lshlrev_b32 v4, 16, v91
  v_and_b32 v5, 0xffff0000, v91
  v_pk_fma_f32 v[46:47], v[4:5], v[22:23], v[46:47] op_sel_hi:[1,0,1]
  v_lshlrev_b32 v2, 16, v92
  v_and_b32 v3, 0xffff0000, v92
  v_pk_fma_f32 v[48:49], v[2:3], v[22:23], v[48:49] op_sel_hi:[1,0,1]
  v_lshlrev_b32 v4, 16, v93
  v_and_b32 v5, 0xffff0000, v93
  v_pk_fma_f32 v[50:51], v[4:5], v[22:23], v[50:51] op_sel_hi:[1,0,1]
  v_lshlrev_b32 v2, 16, v94
  v_and_b32 v3, 0xffff0000, v94
  v_pk_fma_f32 v[52:53], v[2:3], v[22:23], v[52:53] op_sel_hi:[1,0,1]
  v_lshlrev_b32 v4, 16, v95
  v_and_b32 v5, 0xffff0000, v95
  v_pk_fma_f32 v[54:55], v[4:5], v[22:23], v[54:55] op_sel_hi:[1,0,1]
  v_lshlrev_b32 v2, 16, v96
  v_and_b32 v3, 0xffff0000, v96
  v_pk_fma_f32 v[56:57], v[2:3], v[22:23], v[56:57] op_sel_hi:[1,0,1]
  v_lshlrev_b32 v4, 16, v97
  v_and_b32 v5, 0xffff0000, v97
  v_pk_fma_f32 v[58:59], v[4:5], v[22:23], v[58:59] op_sel_hi:[1,0,1]
  v_lshlrev_b32 v2, 16, v98
  v_and_b32 v3, 0xffff0000, v98
  v_pk_fma_f32 v[60:61], v[2:3], v[22:23], v[60:61] op_sel_hi:[1,0,1]
  v_lshlrev_b32 v4, 16, v99
  v_and_b32 v5, 0xffff0000, v99
  v_pk_fma_f32 v[62:63], v[4:5], v[22:23], v[62:63] op_sel_hi:[1,0,1]
  v_fma_f32 v22, v14, s19, -v9
  v_exp_f32 v22, v22
  s_waitcnt vmcnt(5)
  s_bitcmp1_b32 s61, 2
  s_cbranch_scc0 L_w21
  s_waitcnt vmcnt(4)
L_w21:
  s_bitcmp1_b32 s61, 10
  s_cbranch_scc0 L_w22
  s_waitcnt vmcnt(3)
L_w22:
  s_add_u32 s21, s16, 0x1800
  buffer_load_dwordx4 v[88:91], v1, s[4:7], s21 offen nt
  buffer_load_dwordx4 v[92:95], v1, s[4:7], s21 offen offset:128 nt
  buffer_load_dwordx4 v[96:99], v1, s[4:7], s21 offen offset:256 nt
  v_add_f32 v7, v7, v22
  s_waitcnt vmcnt(21)
  v_lshlrev_b32 v2, 16, v100
  v_and_b32 v3, 0xffff0000, v100
  v_pk_fma_f32 v[40:41], v[2:3], v[22:23], v[40:41] op_sel:[0,1,0] op_sel_hi:[1,1,1]
  v_lshlrev_b32 v4, 16, v101
  v_and_b32 v5, 0xffff0000, v101
  v_pk_fma_f32 v[42:43], v[4:5], v[22:23], v[42:43] op_sel:[0,1,0] op_sel_hi:[1,1,1]
  v_lshlrev_b32 v2, 16, v102
  v_and_b32 v3, 0xffff0000, v102
  v_pk_fma_f32 v[44:45], v[2:3], v[22:23], v[44:45] op_sel:[0,1,0] op_sel_hi:[1,1,1]
  v_lshlrev_b32 v4, 16, v103
  v_and_b32 v5, 0xffff0000, v103
  v_pk_fma_f32 v[46:47], v[4:5], v[22:23], v[46:47] op_sel:[0,1,0] op_sel_hi:[1,1,1]
  v_lshlrev_b32 v2, 16, v104
  v_and_b32 v3, 0xffff0000, v104
  v_pk_fma_f32 v[48:49], v[2:3], v[22:23], v[48:49] op_sel:[0,1,0] op_sel_hi:[1,1,1]
  v_lshlrev_b32 v4, 16, v105
  v_and_b32 v5, 0xffff0000, v105
  v_pk_fma_f32 v[50:51], v[4:5], v[22:23], v[50:51] op_sel:[0,1,0] op_sel_hi:[1,1,1]
  v_lshlrev_b32 v2, 16, v106
  v_and_b32 v3, 0xffff0000, v106
  v_pk_fma_f32 v[52:53], v[2:3], v[22:23], v[52:53] op_sel:[0,1,0] op_sel_hi:[1,1,1]
  v_lshlrev_b32 v4, 16, v107
  v_and_b32 v5, 0xffff0000, v107
  v_pk_fma_f32 v[54:55], v[4:5], v[22:23], v[54:55] op_sel:[0,1,0] op_sel_hi:[1,1,1]
  v_lshlrev_b32 v2, 16, v108
  v_and_b32 v3, 0xffff0000, v108
  v_pk_fma_f32 v[56:57], v[2:3], v[22:23], v[56:57] op_sel:[0,1,0] op_sel_hi:[1,1,1]
  v_lshlrev_b32 v4, 16, v109
  v_and_b32 v5, 0xffff0000, v109
  v_pk_fma_f32 v[58:59], v[4:5], v[22:23], v[58:59] op_sel:[0,1,0] op_sel_hi:[1,1,1]
  v_lshlrev_b32 v2, 16, v110
  v_and_b32 v3, 0xffff0000, v110
  v_pk_fma_f32 v[60:61], v[2:3], v[22:23], v[60:61] op_sel:[0,1,0] op_sel_hi:[1,1,1]
  v_lshlrev_b32 v4, 16, v111
  v_and_b32 v5, 0xffff0000, v111
  v_pk_fma_f32 v[62:63], v[4:5], v[22:23], v[62:63] op_sel:[0,1,0] op_sel_hi:[1,1,1]
  v_fma_f32 v23, v15, s19, -v9
  v_exp_f32 v23, v23
  s_waitcnt vmcnt(5)
  s_bitcmp1_b32 s61, 11
  s_cbranch_scc0 L_w23
  s_waitcnt vmcnt(3)
L_w23:
  s_bitcmp1_b32 s61, 19
  s_cbranch_scc0 L_w24
  s_waitcnt vmcnt(2)
L_w24:
  s_add_u32 s21, s16, 0x2400
  buffer_load_dwordx4 v[100:103], v1, s[4:7], s21 offen nt
  buffer_load_dwordx4 v[104:107], v1, s[4:7], s21 offen offset:128 nt
  buffer_load_dwordx4 v[108:111], v1, s[4:7], s21 offen offset:256 nt
  v_add_f32 v7, v7, v23
  s_waitcnt vmcnt(21)
  v_lshlrev_b32 v2, 16, v112
  v_and_b32 v3, 0xffff0000, v112
  v_pk_fma_f32 v[40:41], v[2:3], v[24:25], v[40:41] op_sel_hi:[1,0,1]
  v_lshlrev_b32 v4, 16, v113
  v_and_b32 v5, 0xffff0000, v113
  v_pk_fma_f32 v[42:43], v[4:5], v[24:25], v[42:43] op_sel_hi:[1,0,1]
  v_lshlrev_b32 v2, 16, v114
  v_and_b32 v3, 0xffff0000, v114
  v_pk_fma_f32 v[44:45], v[2:3], v[24:25], v[44:45] op_sel_hi:[1,0,1]
  v_lshlrev_b32 v4, 16, v115
  v_and_b32 v5, 0xffff0000, v115
  v_pk_fma_f32 v[46:47], v[4:5], v[24:25], v[46:47] op_sel_hi:[1,0,1]
  v_lshlrev_b32 v2, 16, v116
  v_and_b32 v3, 0xffff0000, v116
  v_pk_fma_f32 v[48:49], v[2:3], v[24:25], v[48:49] op_sel_hi:[1,0,1]
  v_lshlrev_b32 v4, 16, v117
  v_and_b32 v5, 0xffff0000, v117
  v_pk_fma_f32 v[50:51], v[4:5], v[24:25], v[50:51] op_sel_hi:[1,0,1]
  v_lshlrev_b32 v2, 16, v118
  v_and_b32 v3, 0xffff0000, v118
  v_pk_fma_f32 v[52:53], v[2:3], v[24:25], v[52:53] op_sel_hi:[1,0,1]
  v_lshlrev_b32 v4, 16, v119
  v_and_b32 v5, 0xffff0000, v119
  v_pk_fma_f32 v[54:55], v[4:5], v[24:25], v[54:55] op_sel_hi:[1,0,1]
  v_lshlrev_b32 v2, 16, v120
  v_and_b32 v3, 0xffff0000, v120
  v_pk_fma_f32 v[56:57], v[2:3], v[24:25], v[56:57] op_sel_hi:[1,0,1]
  v_lshlrev_b32 v4, 16, v121
  v_and_b32 v5, 0xffff0000, v121
  v_pk_fma_f32 v[58:59], v[4:5], v[24:25], v[58:59] op_sel_hi:[1,0,1]
  v_lshlrev_b32 v2, 16, v122
  v_and_b32 v3, 0xffff0000, v122
  v_pk_fma_f32 v[60:61], v[2:3], v[24:25], v[60:61] op_sel_hi:[1,0,1]
  v_lshlrev_b32 v4, 16, v123
  v_and_b32 v5, 0xffff0000, v123
  v_pk_fma_f32 v[62:63], v[4:5], v[24:25], v[62:63] op_sel_hi:[1,0,1]
  v_fma_f32 v24, v16, s19, -v9
  v_exp_f32 v24, v24
  s_waitcnt vmcnt(5)
  s_bitcmp1_b32 s61, 4
  s_cbranch_scc0 L_w25
  s_waitcnt vmcnt(4)
L_w25:
  s_bitcmp1_b32 s61, 12
  s_cbranch_scc0 L_w26
  s_waitcnt vmcnt(3)
L_w26:
  buffer_load_dwordx4 v[112:115], v1, s[4:7], s17 offen nt
  buffer_load_dwordx4 v[116:119], v1, s[4:7], s17 offen offset:128 nt
  buffer_load_dwordx4 v[120:123], v1, s[4:7], s17 offen offset:256 nt
  v_add_f32 v7, v7, v24
  global_load_dword v165, v11, s[50:51] sc0
  s_waitcnt vmcnt(21)
  v_lshlrev_b32 v2, 16, v124
  v_and_b32 v3, 0xffff0000, v124
  v_pk_fma_f32 v[40:41], v[2:3], v[24:25], v[40:41] op_sel:[0,1,0] op_sel_hi:[1,1,1]
  v_lshlrev_b32 v4, 16, v125
  v_and_b32 v5, 0xffff0000, v125
  v_pk_fma_f32 v[42:43], v[4:5], v[24:25], v[42:43] op_sel:[0,1,0] op_sel_hi:[1,1,1]
  v_lshlrev_b32 v2, 16, v126
  v_and_b32 v3, 0xffff0000, v126
  v_pk_fma_f32 v[44:45], v[2:3], v[24:25], v[44:45] op_sel:[0,1,0] op_sel_hi:[1,1,1]
  v_lshlrev_b32 v4, 16, v127
  v_and_b32 v5, 0xffff0000, v127
  v_pk_fma_f32 v[46:47], v[4:5], v[24:25], v[46:47] op_sel:[0,1,0] op_sel_hi:[1,1,1]
  v_lshlrev_b32 v2, 16, v128
  v_and_b32 v3, 0xffff0000, v128
  v_pk_fma_f32 v[48:49], v[2:3], v[24:25], v[48:49] op_sel:[0,1,0] op_sel_hi:[1,1,1]
  v_lshlrev_b32 v4, 16, v129
  v_and_b32 v5, 0xffff0000, v129
  v_pk_fma_f32 v[50:51], v[4:5], v[24:25], v[50:51] op_sel:[0,1,0] op_sel_hi:[1,1,1]
  v_lshlrev_b32 v2, 16, v130
  v_and_b32 v3, 0xffff0000, v130
  v_pk_fma_f32 v[52:53], v[2:3], v[24:25], v[52:53] op_sel:[0,1,0] op_sel_hi:[1,1,1]
  v_lshlrev_b32 v4, 16, v131
  v_and_b32 v5, 0xffff0000, v131
  v_pk_fma_f32 v[54:55], v[4:5], v[24:25], v[54:55] op_sel:[0,1,0] op_sel_hi:[1,1,1]
  v_lshlrev_b32 v2, 16, v132
  v_and_b32 v3, 0xffff0000, v132
  v_pk_fma_f32 v[56:57], v[2:3], v[24:25], v[56:57] op_sel:[0,1,0] op_sel_hi:[1,1,1]
  v_lshlrev_b32 v4, 16, v133
  v_and_b32 v5, 0xffff0000, v133
  v_pk_fma_f32 v[58:59], v[4:5], v[24:25], v[58:59] op_sel:[0,1,0] op_sel_hi:[1,1,1]
  v_lshlrev_b32 v2, 16, v134
  v_and_b32 v3, 0xffff0000, v134
  v_pk_fma_f32 v[60:61], v[2:3], v[24:25], v[60:61] op_sel:[0,1,0] op_sel_hi:[1,1,1]
  v_lshlrev_b32 v4, 16, v135
  v_and_b32 v5, 0xffff0000, v135
  v_pk_fma_f32 v[62:63], v[4:5], v[24:25], v[62:63] op_sel:[0,1,0] op_sel_hi:[1,1,1]
  v_fma_f32 v25, v17, s19, -v9
  v_exp_f32 v25, v25
  s_waitcnt vmcnt(5)
  s_bitcmp1_b32 s61, 13
  s_cbranch_scc0 L_w27
  s_waitcnt vmcnt(3)
L_w27:
  s_bitcmp1_b32 s61, 21
  s_cbranch_scc0 L_w28
  s_waitcnt vmcnt(2)
L_w28:
  s_add_u32 s21, s17, 0xc00
  buffer_load_dwordx4 v[124:127], v1, s[4:7], s21 offen nt
  buffer_load_dwordx4 v[128:131], v1, s[4:7], s21 offen offset:128 nt
  buffer_load_dwordx4 v[132:135], v1, s[4:7], s21 offen offset:256 nt
  v_add_f32 v7, v7, v25
  s_waitcnt vmcnt(21)
  v_lshlrev_b32 v2, 16, v136
  v_and_b32 v3, 0xffff0000, v136
  v_pk_fma_f32 v[40:41], v[2:3], v[26:27], v[40:41] op_sel_hi:[1,0,1]
  v_lshlrev_b32 v4, 16, v137
  v_and_b32 v5, 0xffff0000, v137
  v_pk_fma_f32 v[42:43], v[4:5], v[26:27], v[42:43] op_sel_hi:[1,0,1]
  v_lshlrev_b32 v2, 16, v138
  v_and_b32 v3, 0xffff0000, v138
  v_pk_fma_f32 v[44:45], v[2:3], v[26:27], v[44:45] op_sel_hi:[1,0,1]
  v_lshlrev_b32 v4, 16, v139
  v_and_b32 v5, 0xffff0000, v139
  v_pk_fma_f32 v[46:47], v[4:5], v[26:27], v[46:47] op_sel_hi:[1,0,1]
  v_lshlrev_b32 v2, 16, v140
  v_and_b32 v3, 0xffff0000, v140
  v_pk_fma_f32 v[48:49], v[2:3], v[26:27], v[48:49] op_sel_hi:[1,0,1]
  v_lshlrev_b32 v4, 16, v141
  v_and_b32 v5, 0xffff0000, v141
  v_pk_fma_f32 v[50:51], v[4:5], v[26:27], v[50:51] op_sel_hi:[1,0,1]
  v_lshlrev_b32 v2, 16, v142
  v_and_b32 v3, 0xffff0000, v142
  v_pk_fma_f32 v[52:53], v[2:3], v[26:27], v[52:53] op_sel_hi:[1,0,1]
  v_lshlrev_b32 v4, 16, v143
  v_and_b32 v5, 0xffff0000, v143
  v_pk_fma_f32 v[54:55], v[4:5], v[26:27], v[54:55] op_sel_hi:[1,0,1]
  v_lshlrev_b32 v2, 16, v144
  v_and_b32 v3, 0xffff0000, v144
  v_pk_fma_f32 v[56:57], v[2:3], v[26:27], v[56:57] op_sel_hi:[1,0,1]
  v_lshlrev_b32 v4, 16, v145
  v_and_b32 v5, 0xffff0000, v145
  v_pk_fma_f32 v[58:59], v[4:5], v[26:27], v[58:59] op_sel_hi:[1,0,1]
  v_lshlrev_b32 v2, 16, v146
  v_and_b32 v3, 0xffff0000, v146
  v_pk_fma_f32 v[60:61], v[2:3], v[26:27], v[60:61] op_sel_hi:[1,0,1]
  v_lshlrev_b32 v4, 16, v147
  v_and_b32 v5, 0xffff0000, v147
  v_pk_fma_f32 v[62:63], v[4:5], v[26:27], v[62:63] op_sel_hi:[1,0,1]
  v_fma_f32 v26, v18, s19, -v9
  v_exp_f32 v26, v26
  s_waitcnt vmcnt(5)
  s_bitcmp1_b32 s61, 6
  s_cbranch_scc0 L_w29
  s_waitcnt vmcnt(4)
L_w29:
  s_bitcmp1_b32 s61, 14
  s_cbranch_scc0 L_w30
  s_waitcnt vmcnt(3)
L_w30:
  s_add_u32 s21, s17, 0x1800
  buffer_load_dwordx4 v[136:139], v1, s[4:7], s21 offen nt
  buffer_load_dwordx4 v[140:143], v1, s[4:7], s21 offen offset:128 nt
  buffer_load_dwordx4 v[144:147], v1, s[4:7], s21 offen offset:256 nt
  v_add_f32 v7, v7, v26
  s_waitcnt vmcnt(21)
  v_lshlrev_b32 v2, 16, v148
  v_and_b32 v3, 0xffff0000, v148
  v_pk_fma_f32 v[40:41], v[2:3], v[26:27], v[40:41] op_sel:[0,1,0] op_sel_hi:[1,1,1]
  v_lshlrev_b32 v4, 16, v149
  v_and_b32 v5, 0xffff0000, v149
  v_pk_fma_f32 v[42:43], v[4:5], v[26:27], v[42:43] op_sel:[0,1,0] op_sel_hi:[1,1,1]
  v_lshlrev_b32 v2, 16, v150
  v_and_b32 v3, 0xffff0000, v150
  v_pk_fma_f32 v[44:45], v[2:3], v[26:27], v[44:45] op_sel:[0,1,0] op_sel_hi:[1,1,1]
  v_lshlrev_b32 v4, 16, v151
  v_and_b32 v5, 0xffff0000, v151
  v_pk_fma_f32 v[46:47], v[4:5], v[26:27], v[46:47] op_sel:[0,1,0] op_sel_hi:[1,1,1]
  v_lshlrev_b32 v2, 16, v152
  v_and_b32 v3, 0xffff0000, v152
  v_pk_fma_f32 v[48:49], v[2:3], v[26:27], v[48:49] op_sel:[0,1,0] op_sel_hi:[1,1,1]
  v_lshlrev_b32 v4, 16, v153
  v_and_b32 v5, 0xffff0000, v153
  v_pk_fma_f32 v[50:51], v[4:5], v[26:27], v[50:51] op_sel:[0,1,0] op_sel_hi:[1,1,1]
  v_lshlrev_b32 v2, 16, v154
  v_and_b32 v3, 0xffff0000, v154
  v_pk_fma_f32 v[52:53], v[2:3], v[26:27], v[52:53] op_sel:[0,1,0] op_sel_hi:[1,1,1]
  v_lshlrev_b32 v4, 16, v155
  v_and_b32 v5, 0xffff0000, v155
  v_pk_fma_f32 v[54:55], v[4:5], v[26:27], v[54:55] op_sel:[0,1,0] op_sel_hi:[1,1,1]
  v_lshlrev_b32 v2, 16, v156
  v_and_b32 v3, 0xffff0000, v156
  v_pk_fma_f32 v[56:57], v[2:3], v[26:27], v[56:57] op_sel:[0,1,0] op_sel_hi:[1,1,1]
  v_lshlrev_b32 v4, 16, v157
  v_and_b32 v5, 0xffff0000, v157
  v_pk_fma_f32 v[58:59], v[4:5], v[26:27], v[58:59] op_sel:[0,1,0] op_sel_hi:[1,1,1]
  v_lshlrev_b32 v2, 16, v158
  v_and_b32 v3, 0xffff0000, v158
  v_pk_fma_f32 v[60:61], v[2:3], v[26:27], v[60:61] op_sel:[0,1,0] op_sel_hi:[1,1,1]
  v_lshlrev_b32 v4, 16, v159
  v_and_b32 v5, 0xffff0000, v159
  v_pk_fma_f32 v[62:63], v[4:5], v[26:27], v[62:63] op_sel:[0,1,0] op_sel_hi:[1,1,1]
  v_fma_f32 v27, v19, s19, -v9
  v_exp_f32 v27, v27
  s_waitcnt vmcnt(5)
  s_bitcmp1_b32 s61, 15
  s_cbranch_scc0 L_w31
  s_waitcnt vmcnt(3)
L_w31:
  s_bitcmp1_b32 s61, 23
  s_cbranch_scc0 L_w32
  s_waitcnt vmcnt(2)
L_w32:
  s_add_u32 s21, s17, 0x2400
  buffer_load_dwordx4 v[148:151], v1, s[4:7], s21 offen nt
  buffer_load_dwordx4 v[152:155], v1, s[4:7], s21 offen offset:128 nt
  buffer_load_dwordx4 v[156:159], v1, s[4:7], s21 offen offset:256 nt
  v_add_f32 v7, v7, v27
  s_waitcnt vmcnt(9)
  v_readfirstlane_b32 s52, v165
  s_add_u32 s55, s55, 8
  s_sub_u32 s56, s55, s52
  s_add_u32 s57, s56, 8
  s_cmp_lt_u32 s57, 80
  s_cselect_b32 s57, s52, 0
  s_cmp_gt_u32 s55, 8
  s_cselect_b32 s57, s57, 0
  s_cmp_eq_u32 s57, 0
  s_cselect_b32 s56, -64, s56
  s_cmp_eq_u32 s53, 0
  s_cbranch_scc1 L_f16
  s_lshr_b32 s57, s55, 3
  v_mov_b32 v164, s57
  ds_write_b32 v11, v164 offset:20000
L_f16:
  s_add_u32 s16, s16, 98304
  s_sub_u32 s32, s16, 1572864
  s_cmp_ge_u32 s16, 1572864
  s_cselect_b32 s16, s32, s16
  s_add_u32 s17, s17, 98304
  s_sub_u32 s32, s17, 1572864
  s_cmp_ge_u32 s17, 1572864
  s_cselect_b32 s17, s32, s17
  s_sub_u32 s18, s18, 1
  s_cmp_lg_u32 s18, 0
  s_cbranch_scc1 L_vd
  ds_read_b128 v[12:15], v161
  ds_read_b128 v[16:19], v161 offset:16
  v_add_u32 v161, 0x100, v161
  s_waitcnt vmcnt(21)
  v_lshlrev_b32 v2, 16, v64
  v_and_b32 v3, 0xffff0000, v64
  v_pk_fma_f32 v[40:41], v[2:3], v[20:21], v[40:41] op_sel_hi:[1,0,1]
  v_lshlrev_b32 v4, 16, v65
  v_and_b32 v5, 0xffff0000, v65
  v_pk_fma_f32 v[42:43], v[4:5], v[20:21], v[42:43] op_sel_hi:[1,0,1]
  v_lshlrev_b32 v2, 16, v66
  v_and_b32 v3, 0xffff0000, v66
  v_pk_fma_f32 v[44:45], v[2:3], v[20:21], v[44:45] op_sel_hi:[1,0,1]
  v_lshlrev_b32 v4, 16, v67
  v_and_b32 v5, 0xffff0000, v67
  v_pk_fma_f32 v[46:47], v[4:5], v[20:21], v[46:47] op_sel_hi:[1,0,1]
  v_lshlrev_b32 v2, 16, v68
  v_and_b32 v3, 0xffff0000, v68
  v_pk_fma_f32 v[48:49], v[2:3], v[20:21], v[48:49] op_sel_hi:[1,0,1]
  v_lshlrev_b32 v4, 16, v69
  v_and_b32 v5, 0xffff0000, v69
  v_pk_fma_f32 v[50:51], v[4:5], v[20:21], v[50:51] op_sel_hi:[1,0,1]
  v_lshlrev_b32 v2, 16, v70
  v_and_b32 v3, 0xffff0000, v70
  v_pk_fma_f32 v[52:53], v[2:3], v[20:21], v[52:53] op_sel_hi:[1,0,1]
  v_lshlrev_b32 v4, 16, v71
  v_and_b32 v5, 0xffff0000, v71
  v_pk_fma_f32 v[54:55], v[4:5], v[20:21], v[54:55] op_sel_hi:[1,0,1]
  v_lshlrev_b32 v2, 16, v72
  v_and_b32 v3, 0xffff0000, v72
  v_pk_fma_f32 v[56:57], v[2:3], v[20:21], v[56:57] op_sel_hi:[1,0,1]
  v_lshlrev_b32 v4, 16, v73
  v_and_b32 v5, 0xffff0000, v73
  v_pk_fma_f32 v[58:59], v[4:5], v[20:21], v[58:59] op_sel_hi:[1,0,1]
  v_lshlrev_b32 v2, 16, v74
  v_and_b32 v3, 0xffff0000, v74
  v_pk_fma_f32 v[60:61], v[2:3], v[20:21], v[60:61] op_sel_hi:[1,0,1]
  v_lshlrev_b32 v4, 16, v75
  v_and_b32 v5, 0xffff0000, v75
  v_pk_fma_f32 v[62:63], v[4:5], v[20:21], v[62:63] op_sel_hi:[1,0,1]
  s_waitcnt lgkmcnt(0)
  v_fma_f32 v20, v12, s19, -v9
  v_exp_f32 v20, v20
  buffer_load_dwordx4 v[64:67], v1, s[4:7], s16 offen nt
  buffer_load_dwordx4 v[68:71], v1, s[4:7], s16 offen offset:128 nt
  buffer_load_dwordx4 v[72:75], v1, s[4:7], s16 offen offset:256 nt
  v_add_f32 v7, v7, v20
  s_waitcnt vmcnt(21)
  v_lshlrev_b32 v2, 16, v76
  v_and_b32 v3, 0xffff0000, v76
  v_pk_fma_f32 v[40:41], v[2:3], v[20:21], v[40:41] op_sel:[0,1,0] op_sel_hi:[1,1,1]
  v_lshlrev_b32 v4, 16, v77
  v_and_b32 v5, 0xffff0000, v77
  v_pk_fma_f32 v[42:43], v[4:5], v[20:21], v[42:43] op_sel:[0,1,0] op_sel_hi:[1,1,1]
  v_lshlrev_b32 v2, 16, v78
  v_and_b32 v3, 0xffff0000, v78
  v_pk_fma_f32 v[44:45], v[2:3], v[20:21], v[44:45] op_sel:[0,1,0] op_sel_hi:[1,1,1]
  v_lshlrev_b32 v4, 16, v79
  v_and_b32 v5, 0xffff0000, v79
  v_pk_fma_f32 v[46:47], v[4:5], v[20:21], v[46:47] op_sel:[0,1,0] op_sel_hi:[1,1,1]
  v_lshlrev_b32 v2, 16, v80
  v_and_b32 v3, 0xffff0000, v80
  v_pk_fma_f32 v[48:49], v[2:3], v[20:21], v[48:49] op_sel:[0,1,0] op_sel_hi:[1,1,1]
  v_lshlrev_b32 v4, 16, v81
  v_and_b32 v5, 0xffff0000, v81
  v_pk_fma_f32 v[50:51], v[4:5], v[20:21], v[50:51] op_sel:[0,1,0] op_sel_hi:[1,1,1]
  v_lshlrev_b32 v2, 16, v82
  v_and_b32 v3, 0xffff0000, v82
  v_pk_fma_f32 v[52:53], v[2:3], v[20:21], v[52:53] op_sel:[0,1,0] op_sel_hi:[1,1,1]
  v_lshlrev_b32 v4, 16, v83
  v_and_b32 v5, 0xffff0000, v83
  v_pk_fma_f32 v[54:55], v[4:5], v[20:21], v[54:55] op_sel:[0,1,0] op_sel_hi:[1,1,1]
  v_lshlrev_b32 v2, 16, v84
  v_and_b32 v3, 0xffff0000, v84
  v_pk_fma_f32 v[56:57], v[2:3], v[20:21], v[56:57] op_sel:[0,1,0] op_sel_hi:[1,1,1]
  v_lshlrev_b32 v4, 16, v85
  v_and_b32 v5, 0xffff0000, v85
  v_pk_fma_f32 v[58:59], v[4:5], v[20:21], v[58:59] op_sel:[0,1,0] op_sel_hi:[1,1,1]
  v_lshlrev_b32 v2, 16, v86
  v_and_b32 v3, 0xffff0000, v86
  v_pk_fma_f32 v[60:61], v[2:3], v[20:21], v[60:61] op_sel:[0,1,0] op_sel_hi:[1,1,1]
  v_lshlrev_b32 v4, 16, v87
  v_and_b32 v5, 0xffff0000, v87
  v_pk_fma_f32 v[62:63], v[4:5], v[20:21], v[62:63] op_sel:[0,1,0] op_sel_hi:[1,1,1]
  v_fma_f32 v21, v13, s19, -v9
  v_exp_f32 v21, v21
  s_add_u32 s21, s16, 0xc00
  buffer_load_dwordx4 v[76:79], v1, s[4:7], s21 offen nt
  buffer_load_dwordx4 v[80:83], v1, s[4:7], s21 offen offset:128 nt
  buffer_load_dwordx4 v[84:87], v1, s[4:7], s21 offen offset:256 nt
  v_add_f32 v7, v7, v21
  s_waitcnt vmcnt(21)
  v_lshlrev_b32 v2, 16, v88
  v_and_b32 v3, 0xffff0000, v88
  v_pk_fma_f32 v[40:41], v[2:3], v[22:23], v[40:41] op_sel_hi:[1,0,1]
  v_lshlrev_b32 v4, 16, v89
  v_and_b32 v5, 0xffff0000, v89
  v_pk_fma_f32 v[42:43], v[4:5], v[22:23], v[42:43] op_sel_hi:[1,0,1]
  v_lshlrev_b32 v2, 16, v90
  v_and_b32 v3, 0xffff0000, v90
  v_pk_fma_f32 v[44:45], v[2:3], v[22:23], v[44:45] op_sel_hi:[1,0,1]
  v_lshlrev_b32 v4, 16, v91
  v_and_b32 v5, 0xffff0000, v91
  v_pk_fma_f32 v[46:47], v[4:5], v[22:23], v[46:47] op_sel_hi:[1,0,1]
  v_lshlrev_b32 v2, 16, v92
  v_and_b32 v3, 0xffff0000, v92
  v_pk_fma_f32 v[48:49], v[2:3], v[22:23], v[48:49] op_sel_hi:[1,0,1]
  v_lshlrev_b32 v4, 16, v93
  v_and_b32 v5, 0xffff0000, v93
  v_pk_fma_f32 v[50:51], v[4:5], v[22:23], v[50:51] op_sel_hi:[1,0,1]
  v_lshlrev_b32 v2, 16, v94
  v_and_b32 v3, 0xffff0000, v94
  v_pk_fma_f32 v[52:53], v[2:3], v[22:23], v[52:53] op_sel_hi:[1,0,1]
  v_lshlrev_b32 v4, 16, v95
  v_and_b32 v5, 0xffff0000, v95
  v_pk_fma_f32 v[54:55], v[4:5], v[22:23], v[54:55] op_sel_hi:[1,0,1]
  v_lshlrev_b32 v2, 16, v96
  v_and_b32 v3, 0xffff0000, v96
  v_pk_fma_f32 v[56:57], v[2:3], v[22:23], v[56:57] op_sel_hi:[1,0,1]
  v_lshlrev_b32 v4, 16, v97
  v_and_b32 v5, 0xffff0000, v97
  v_pk_fma_f32 v[58:59], v[4:5], v[22:23], v[58:59] op_sel_hi:[1,0,1]
  v_lshlrev_b32 v2, 16, v98
  v_and_b32 v3, 0xffff0000, v98
  v_pk_fma_f32 v[60:61], v[2:3], v[22:23], v[60:61] op_sel_hi:[1,0,1]
  v_lshlrev_b32 v4, 16, v99
  v_and_b32 v5, 0xffff0000, v99
  v_pk_fma_f32 v[62:63], v[4:5], v[22:23], v[62:63] op_sel_hi:[1,0,1]
  v_fma_f32 v22, v14, s19, -v9
  v_exp_f32 v22, v22
  s_add_u32 s21, s16, 0x1800
  buffer_load_dwordx4 v[88:91], v1, s[4:7], s21 offen nt
  buffer_load_dwordx4 v[92:95], v1, s[4:7], s21 offen offset:128 nt
  buffer_load_dwordx4 v[96:99], v1, s[4:7], s21 offen offset:256 nt
  v_add_f32 v7, v7, v22
  s_waitcnt vmcnt(21)
  v_lshlrev_b32 v2, 16, v100
  v_and_b32 v3, 0xffff0000, v100
  v_pk_fma_f32 v[40:41], v[2:3], v[22:23], v[40:41] op_sel:[0,1,0] op_sel_hi:[1,1,1]
  v_lshlrev_b32 v4, 16, v101
  v_and_b32 v5, 0xffff0000, v101
  v_pk_fma_f32 v[42:43], v[4:5], v[22:23], v[42:43] op_sel:[0,1,0] op_sel_hi:[1,1,1]
  v_lshlrev_b32 v2, 16, v102
  v_and_b32 v3, 0xffff0000, v102
  v_pk_fma_f32 v[44:45], v[2:3], v[22:23], v[44:45] op_sel:[0,1,0] op_sel_hi:[1,1,1]
  v_lshlrev_b32 v4, 16, v103
  v_and_b32 v5, 0xffff0000, v103
  v_pk_fma_f32 v[46:47], v[4:5], v[22:23], v[46:47] op_sel:[0,1,0] op_sel_hi:[1,1,1]
  v_lshlrev_b32 v2, 16, v104
  v_and_b32 v3, 0xffff0000, v104
  v_pk_fma_f32 v[48:49], v[2:3], v[22:23], v[48:49] op_sel:[0,1,0] op_sel_hi:[1,1,1]
  v_lshlrev_b32 v4, 16, v105
  v_and_b32 v5, 0xffff0000, v105
  v_pk_fma_f32 v[50:51], v[4:5], v[22:23], v[50:51] op_sel:[0,1,0] op_sel_hi:[1,1,1]
  v_lshlrev_b32 v2, 16, v106
  v_and_b32 v3, 0xffff0000, v106
  v_pk_fma_f32 v[52:53], v[2:3], v[22:23], v[52:53] op_sel:[0,1,0] op_sel_hi:[1,1,1]
  v_lshlrev_b32 v4, 16, v107
  v_and_b32 v5, 0xffff0000, v107
  v_pk_fma_f32 v[54:55], v[4:5], v[22:23], v[54:55] op_sel:[0,1,0] op_sel_hi:[1,1,1]
  v_lshlrev_b32 v2, 16, v108
  v_and_b32 v3, 0xffff0000, v108
  v_pk_fma_f32 v[56:57], v[2:3], v[22:23], v[56:57] op_sel:[0,1,0] op_sel_hi:[1,1,1]
  v_lshlrev_b32 v4, 16, v109
  v_and_b32 v5, 0xffff0000, v109
  v_pk_fma_f32 v[58:59], v[4:5], v[22:23], v[58:59] op_sel:[0,1,0] op_sel_hi:[1,1,1]
  v_lshlrev_b32 v2, 16, v110
  v_and_b32 v3, 0xffff0000, v110
  v_pk_fma_f32 v[60:61], v[2:3], v[22:23], v[60:61] op_sel:[0,1,0] op_sel_hi:[1,1,1]
  v_lshlrev_b32 v4, 16, v111
  v_and_b32 v5, 0xffff0000, v111
  v_pk_fma_f32 v[62:63], v[4:5], v[22:23], v[62:63] op_sel:[0,1,0] op_sel_hi:[1,1,1]
  v_fma_f32 v23, v15, s19, -v9
  v_exp_f32 v23, v23
  s_add_u32 s21, s16, 0x2400
  buffer_load_dwordx4 v[100:103], v1, s[4:7], s21 offen nt
  buffer_load_dwordx4 v[104:107], v1, s[4:7], s21 offen offset:128 nt
  buffer_load_dwordx4 v[108:111], v1, s[4:7], s21 offen offset:256 nt
  v_add_f32 v7, v7, v23
  s_waitcnt vmcnt(21)
  v_lshlrev_b32 v2, 16, v112
  v_and_b32 v3, 0xffff0000, v112
  v_pk_fma_f32 v[40:41], v[2:3], v[24:25], v[40:41] op_sel_hi:[1,0,1]
  v_lshlrev_b32 v4, 16, v113
  v_and_b32 v5, 0xffff0000, v113
  v_pk_fma_f32 v[42:43], v[4:5], v[24:25], v[42:43] op_sel_hi:[1,0,1]
  v_lshlrev_b32 v2, 16, v114
  v_and_b32 v3, 0xffff0000, v114
  v_pk_fma_f32 v[44:45], v[2:3], v[24:25], v[44:45] op_sel_hi:[1,0,1]
  v_lshlrev_b32 v4, 16, v115
  v_and_b32 v5, 0xffff0000, v115
  v_pk_fma_f32 v[46:47], v[4:5], v[24:25], v[46:47] op_sel_hi:[1,0,1]
  v_lshlrev_b32 v2, 16, v116
  v_and_b32 v3, 0xffff0000, v116
  v_pk_fma_f32 v[48:49], v[2:3], v[24:25], v[48:49] op_sel_hi:[1,0,1]
  v_lshlrev_b32 v4, 16, v117
  v_and_b32 v5, 0xffff0000, v117
  v_pk_fma_f32 v[50:51], v[4:5], v[24:25], v[50:51] op_sel_hi:[1,0,1]
  v_lshlrev_b32 v2, 16, v118
  v_and_b32 v3, 0xffff0000, v118
  v_pk_fma_f32 v[52:53], v[2:3], v[24:25], v[52:53] op_sel_hi:[1,0,1]
  v_lshlrev_b32 v4, 16, v119
  v_and_b32 v5, 0xffff0000, v119
  v_pk_fma_f32 v[54:55], v[4:5], v[24:25], v[54:55] op_sel_hi:[1,0,1]
  v_lshlrev_b32 v2, 16, v120
  v_and_b32 v3, 0xffff0000, v120
  v_pk_fma_f32 v[56:57], v[2:3], v[24:25], v[56:57] op_sel_hi:[1,0,1]
  v_lshlrev_b32 v4, 16, v121
  v_and_b32 v5, 0xffff0000, v121
  v_pk_fma_f32 v[58:59], v[4:5], v[24:25], v[58:59] op_sel_hi:[1,0,1]
  v_lshlrev_b32 v2, 16, v122
  v_and_b32 v3, 0xffff0000, v122
  v_pk_fma_f32 v[60:61], v[2:3], v[24:25], v[60:61] op_sel_hi:[1,0,1]
  v_lshlrev_b32 v4, 16, v123
  v_and_b32 v5, 0xffff0000, v123
  v_pk_fma_f32 v[62:63], v[4:5], v[24:25], v[62:63] op_sel_hi:[1,0,1]
  v_fma_f32 v24, v16, s19, -v9
  v_exp_f32 v24, v24
  buffer_load_dwordx4 v[112:115], v1, s[4:7], s17 offen nt
  buffer_load_dwordx4 v[116:119], v1, s[4:7], s17 offen offset:128 nt
  buffer_load_dwordx4 v[120:123], v1, s[4:7], s17 offen offset:256 nt
  v_add_f32 v7, v7, v24
  s_waitcnt vmcnt(21)
  v_lshlrev_b32 v2, 16, v124
  v_and_b32 v3, 0xffff0000, v124
  v_pk_fma_f32 v[40:41], v[2:3], v[24:25], v[40:41] op_sel:[0,1,0] op_sel_hi:[1,1,1]
  v_lshlrev_b32 v4, 16, v125
  v_and_b32 v5, 0xffff0000, v125
  v_pk_fma_f32 v[42:43], v[4:5], v[24:25], v[42:43] op_sel:[0,1,0] op_sel_hi:[1,1,1]
  v_lshlrev_b32 v2, 16, v126
  v_and_b32 v3, 0xffff0000, v126
  v_pk_fma_f32 v[44:45], v[2:3], v[24:25], v[44:45] op_sel:[0,1,0] op_sel_hi:[1,1,1]
  v_lshlrev_b32 v4, 16, v127
  v_and_b32 v5, 0xffff0000, v127
  v_pk_fma_f32 v[46:47], v[4:5], v[24:25], v[46:47] op_sel:[0,1,0] op_sel_hi:[1,1,1]
  v_lshlrev_b32 v2, 16, v128
  v_and_b32 v3, 0xffff0000, v128
  v_pk_fma_f32 v[48:49], v[2:3], v[24:25], v[48:49] op_sel:[0,1,0] op_sel_hi:[1,1,1]
  v_lshlrev_b32 v4, 16, v129
  v_and_b32 v5, 0xffff0000, v129
  v_pk_fma_f32 v[50:51], v[4:5], v[24:25], v[50:51] op_sel:[0,1,0] op_sel_hi:[1,1,1]
  v_lshlrev_b32 v2, 16, v130
  v_and_b32 v3, 0xffff0000, v130
  v_pk_fma_f32 v[52:53], v[2:3], v[24:25], v[52:53] op_sel:[0,1,0] op_sel_hi:[1,1,1]
  v_lshlrev_b32 v4, 16, v131
  v_and_b32 v5, 0xffff0000, v131
  v_pk_fma_f32 v[54:55], v[4:5], v[24:25], v[54:55] op_sel:[0,1,0] op_sel_hi:[1,1,1]
  v_lshlrev_b32 v2, 16, v132
  v_and_b32 v3, 0xffff0000, v132
  v_pk_fma_f32 v[56:57], v[2:3], v[24:25], v[56:57] op_sel:[0,1,0] op_sel_hi:[1,1,1]
  v_lshlrev_b32 v4, 16, v133
  v_and_b32 v5, 0xffff0000, v133
  v_pk_fma_f32 v[58:59], v[4:5], v[24:25], v[58:59] op_sel:[0,1,0] op_sel_hi:[1,1,1]
  v_lshlrev_b32 v2, 16, v134
  v_and_b32 v3, 0xffff0000, v134
  v_pk_fma_f32 v[60:61], v[2:3], v[24:25], v[60:61] op_sel:[0,1,0] op_sel_hi:[1,1,1]
  v_lshlrev_b32 v4, 16, v135
  v_and_b32 v5, 0xffff0000, v135
  v_pk_fma_f32 v[62:63], v[4:5], v[24:25], v[62:63] op_sel:[0,1,0] op_sel_hi:[1,1,1]
  v_fma_f32 v25, v17, s19, -v9
  v_exp_f32 v25, v25
  s_add_u32 s21, s17, 0xc00
  buffer_load_dwordx4 v[124:127], v1, s[4:7], s21 offen nt
  buffer_load_dwordx4 v[128:131], v1, s[4:7], s21 offen offset:128 nt
  buffer_load_dwordx4 v[132:135], v1, s[4:7], s21 offen offset:256 nt
  v_add_f32 v7, v7, v25
  s_waitcnt vmcnt(21)
  v_lshlrev_b32 v2, 16, v136
  v_and_b32 v3, 0xffff0000, v136
  v_pk_fma_f32 v[40:41], v[2:3], v[26:27], v[40:41] op_sel_hi:[1,0,1]
  v_lshlrev_b32 v4, 16, v137
  v_and_b32 v5, 0xffff0000, v137
  v_pk_fma_f32 v[42:43], v[4:5], v[26:27], v[42:43] op_sel_hi:[1,0,1]
  v_lshlrev_b32 v2, 16, v138
  v_and_b32 v3, 0xffff0000, v138
  v_pk_fma_f32 v[44:45], v[2:3], v[26:27], v[44:45] op_sel_hi:[1,0,1]
  v_lshlrev_b32 v4, 16, v139
  v_and_b32 v5, 0xffff0000, v139
  v_pk_fma_f32 v[46:47], v[4:5], v[26:27], v[46:47] op_sel_hi:[1,0,1]
  v_lshlrev_b32 v2, 16, v140
  v_and_b32 v3, 0xffff0000, v140
  v_pk_fma_f32 v[48:49], v[2:3], v[26:27], v[48:49] op_sel_hi:[1,0,1]
  v_lshlrev_b32 v4, 16, v141
  v_and_b32 v5, 0xffff0000, v141
  v_pk_fma_f32 v[50:51], v[4:5], v[26:27], v[50:51] op_sel_hi:[1,0,1]
  v_lshlrev_b32 v2, 16, v142
  v_and_b32 v3, 0xffff0000, v142
  v_pk_fma_f32 v[52:53], v[2:3], v[26:27], v[52:53] op_sel_hi:[1,0,1]
  v_lshlrev_b32 v4, 16, v143
  v_and_b32 v5, 0xffff0000, v143
  v_pk_fma_f32 v[54:55], v[4:5], v[26:27], v[54:55] op_sel_hi:[1,0,1]
  v_lshlrev_b32 v2, 16, v144
  v_and_b32 v3, 0xffff0000, v144
  v_pk_fma_f32 v[56:57], v[2:3], v[26:27], v[56:57] op_sel_hi:[1,0,1]
  v_lshlrev_b32 v4, 16, v145
  v_and_b32 v5, 0xffff0000, v145
  v_pk_fma_f32 v[58:59], v[4:5], v[26:27], v[58:59] op_sel_hi:[1,0,1]
  v_lshlrev_b32 v2, 16, v146
  v_and_b32 v3, 0xffff0000, v146
  v_pk_fma_f32 v[60:61], v[2:3], v[26:27], v[60:61] op_sel_hi:[1,0,1]
  v_lshlrev_b32 v4, 16, v147
  v_and_b32 v5, 0xffff0000, v147
  v_pk_fma_f32 v[62:63], v[4:5], v[26:27], v[62:63] op_sel_hi:[1,0,1]
  v_fma_f32 v26, v18, s19, -v9
  v_exp_f32 v26, v26
  s_add_u32 s21, s17, 0x1800
  buffer_load_dwordx4 v[136:139], v1, s[4:7], s21 offen nt
  buffer_load_dwordx4 v[140:143], v1, s[4:7], s21 offen offset:128 nt
  buffer_load_dwordx4 v[144:147], v1, s[4:7], s21 offen offset:256 nt
  v_add_f32 v7, v7, v26
  s_waitcnt vmcnt(21)
  v_lshlrev_b32 v2, 16, v148
  v_and_b32 v3, 0xffff0000, v148
  v_pk_fma_f32 v[40:41], v[2:3], v[26:27], v[40:41] op_sel:[0,1,0] op_sel_hi:[1,1,1]
  v_lshlrev_b32 v4, 16, v149
  v_and_b32 v5, 0xffff0000, v149
  v_pk_fma_f32 v[42:43], v[4:5], v[26:27], v[42:43] op_sel:[0,1,0] op_sel_hi:[1,1,1]
  v_lshlrev_b32 v2, 16, v150
  v_and_b32 v3, 0xffff0000, v150
  v_pk_fma_f32 v[44:45], v[2:3], v[26:27], v[44:45] op_sel:[0,1,0] op_sel_hi:[1,1,1]
  v_lshlrev_b32 v4, 16, v151
  v_and_b32 v5, 0xffff0000, v151
  v_pk_fma_f32 v[46:47], v[4:5], v[26:27], v[46:47] op_sel:[0,1,0] op_sel_hi:[1,1,1]
  v_lshlrev_b32 v2, 16, v152
  v_and_b32 v3, 0xffff0000, v152
  v_pk_fma_f32 v[48:49], v[2:3], v[26:27], v[48:49] op_sel:[0,1,0] op_sel_hi:[1,1,1]
  v_lshlrev_b32 v4, 16, v153
  v_and_b32 v5, 0xffff0000, v153
  v_pk_fma_f32 v[50:51], v[4:5], v[26:27], v[50:51] op_sel:[0,1,0] op_sel_hi:[1,1,1]
  v_lshlrev_b32 v2, 16, v154
  v_and_b32 v3, 0xffff0000, v154
  v_pk_fma_f32 v[52:53], v[2:3], v[26:27], v[52:53] op_sel:[0,1,0] op_sel_hi:[1,1,1]
  v_lshlrev_b32 v4, 16, v155
  v_and_b32 v5, 0xffff0000, v155
  v_pk_fma_f32 v[54:55], v[4:5], v[26:27], v[54:55] op_sel:[0,1,0] op_sel_hi:[1,1,1]
  v_lshlrev_b32 v2, 16, v156
  v_and_b32 v3, 0xffff0000, v156
  v_pk_fma_f32 v[56:57], v[2:3], v[26:27], v[56:57] op_sel:[0,1,0] op_sel_hi:[1,1,1]
  v_lshlrev_b32 v4, 16, v157
  v_and_b32 v5, 0xffff0000, v157
  v_pk_fma_f32 v[58:59], v[4:5], v[26:27], v[58:59] op_sel:[0,1,0] op_sel_hi:[1,1,1]
  v_lshlrev_b32 v2, 16, v158
  v_and_b32 v3, 0xffff0000, v158
  v_pk_fma_f32 v[60:61], v[2:3], v[26:27], v[60:61] op_sel:[0,1,0] op_sel_hi:[1,1,1]
  v_lshlrev_b32 v4, 16, v159
  v_and_b32 v5, 0xffff0000, v159
  v_pk_fma_f32 v[62:63], v[4:5], v[26:27], v[62:63] op_sel:[0,1,0] op_sel_hi:[1,1,1]
  v_fma_f32 v27, v19, s19, -v9
  v_exp_f32 v27, v27
  s_add_u32 s21, s17, 0x2400
  buffer_load_dwordx4 v[148:151], v1, s[4:7], s21 offen nt
  buffer_load_dwordx4 v[152:155], v1, s[4:7], s21 offen offset:128 nt
  buffer_load_dwordx4 v[156:159], v1, s[4:7], s21 offen offset:256 nt
  v_add_f32 v7, v7, v27
  s_add_u32 s16, s16, 98304
  s_sub_u32 s32, s16, 1572864
  s_cmp_ge_u32 s16, 1572864
  s_cselect_b32 s16, s32, s16
  s_add_u32 s17, s17, 98304
  s_sub_u32 s32, s17, 1572864
  s_cmp_ge_u32 s17, 1572864
  s_cselect_b32 s17, s32, s17
  s_waitcnt vmcnt(21)
  v_lshlrev_b32 v2, 16, v64
  v_and_b32 v3, 0xffff0000, v64
  v_pk_fma_f32 v[40:41], v[2:3], v[20:21], v[40:41] op_sel_hi:[1,0,1]
  v_lshlrev_b32 v4, 16, v65
  v_and_b32 v5, 0xffff0000, v65
  v_pk_fma_f32 v[42:43], v[4:5], v[20:21], v[42:43] op_sel_hi:[1,0,1]
  v_lshlrev_b32 v2, 16, v66
  v_and_b32 v3, 0xffff0000, v66
  v_pk_fma_f32 v[44:45], v[2:3], v[20:21], v[44:45] op_sel_hi:[1,0,1]
  v_lshlrev_b32 v4, 16, v67
  v_and_b32 v5, 0xffff0000, v67
  v_pk_fma_f32 v[46:47], v[4:5], v[20:21], v[46:47] op_sel_hi:[1,0,1]
  v_lshlrev_b32 v2, 16, v68
  v_and_b32 v3, 0xffff0000, v68
  v_pk_fma_f32 v[48:49], v[2:3], v[20:21], v[48:49] op_sel_hi:[1,0,1]
  v_lshlrev_b32 v4, 16, v69
  v_and_b32 v5, 0xffff0000, v69
  v_pk_fma_f32 v[50:51], v[4:5], v[20:21], v[50:51] op_sel_hi:[1,0,1]
  v_lshlrev_b32 v2, 16, v70
  v_and_b32 v3, 0xffff0000, v70
  v_pk_fma_f32 v[52:53], v[2:3], v[20:21], v[52:53] op_sel_hi:[1,0,1]
  v_lshlrev_b32 v4, 16, v71
  v_and_b32 v5, 0xffff0000, v71
  v_pk_fma_f32 v[54:55], v[4:5], v[20:21], v[54:55] op_sel_hi:[1,0,1]
  v_lshlrev_b32 v2, 16, v72
  v_and_b32 v3, 0xffff0000, v72
  v_pk_fma_f32 v[56:57], v[2:3], v[20:21], v[56:57] op_sel_hi:[1,0,1]
  v_lshlrev_b32 v4, 16, v73
  v_and_b32 v5, 0xffff0000, v73
  v_pk_fma_f32 v[58:59], v[4:5], v[20:21], v[58:59] op_sel_hi:[1,0,1]
  v_lshlrev_b32 v2, 16, v74
  v_and_b32 v3, 0xffff0000, v74
  v_pk_fma_f32 v[60:61], v[2:3], v[20:21], v[60:61] op_sel_hi:[1,0,1]
  v_lshlrev_b32 v4, 16, v75
  v_and_b32 v5, 0xffff0000, v75
  v_pk_fma_f32 v[62:63], v[4:5], v[20:21], v[62:63] op_sel_hi:[1,0,1]
  s_waitcnt vmcnt(18)
  v_lshlrev_b32 v2, 16, v76
  v_and_b32 v3, 0xffff0000, v76
  v_pk_fma_f32 v[40:41], v[2:3], v[20:21], v[40:41] op_sel:[0,1,0] op_sel_hi:[1,1,1]
  v_lshlrev_b32 v4, 16, v77
  v_and_b32 v5, 0xffff0000, v77
  v_pk_fma_f32 v[42:43], v[4:5], v[20:21], v[42:43] op_sel:[0,1,0] op_sel_hi:[1,1,1]
  v_lshlrev_b32 v2, 16, v78
  v_and_b32 v3, 0xffff0000, v78
  v_pk_fma_f32 v[44:45], v[2:3], v[20:21], v[44:45] op_sel:[0,1,0] op_sel_hi:[1,1,1]
  v_lshlrev_b32 v4, 16, v79
  v_and_b32 v5, 0xffff0000, v79
  v_pk_fma_f32 v[46:47], v[4:5], v[20:21], v[46:47] op_sel:[0,1,0] op_sel_hi:[1,1,1]
  v_lshlrev_b32 v2, 16, v80
  v_and_b32 v3, 0xffff0000, v80
  v_pk_fma_f32 v[48:49], v[2:3], v[20:21], v[48:49] op_sel:[0,1,0] op_sel_hi:[1,1,1]
  v_lshlrev_b32 v4, 16, v81
  v_and_b32 v5, 0xffff0000, v81
  v_pk_fma_f32 v[50:51], v[4:5], v[20:21], v[50:51] op_sel:[0,1,0] op_sel_hi:[1,1,1]
  v_lshlrev_b32 v2, 16, v82
  v_and_b32 v3, 0xffff0000, v82
  v_pk_fma_f32 v[52:53], v[2:3], v[20:21], v[52:53] op_sel:[0,1,0] op_sel_hi:[1,1,1]
  v_lshlrev_b32 v4, 16, v83
  v_and_b32 v5, 0xffff0000, v83
  v_pk_fma_f32 v[54:55], v[4:5], v[20:21], v[54:55] op_sel:[0,1,0] op_sel_hi:[1,1,1]
  v_lshlrev_b32 v2, 16, v84
  v_and_b32 v3, 0xffff0000, v84
  v_pk_fma_f32 v[56:57], v[2:3], v[20:21], v[56:57] op_sel:[0,1,0] op_sel_hi:[1,1,1]
  v_lshlrev_b32 v4, 16, v85
  v_and_b32 v5, 0xffff0000, v85
  v_pk_fma_f32 v[58:59], v[4:5], v[20:21], v[58:59] op_sel:[0,1,0] op_sel_hi:[1,1,1]
  v_lshlrev_b32 v2, 16, v86
  v_and_b32 v3, 0xffff0000, v86
  v_pk_fma_f32 v[60:61], v[2:3], v[20:21], v[60:61] op_sel:[0,1,0] op_sel_hi:[1,1,1]
  v_lshlrev_b32 v4, 16, v87
  v_and_b32 v5, 0xffff0000, v87
  v_pk_fma_f32 v[62:63], v[4:5], v[20:21], v[62:63] op_sel:[0,1,0] op_sel_hi:[1,1,1]
  s_waitcnt vmcnt(15)
  v_lshlrev_b32 v2, 16, v88
  v_and_b32 v3, 0xffff0000, v88
  v_pk_fma_f32 v[40:41], v[2:3], v[22:23], v[40:41] op_sel_hi:[1,0,1]
  v_lshlrev_b32 v4, 16, v89
  v_and_b32 v5, 0xffff0000, v89
  v_pk_fma_f32 v[42:43], v[4:5], v[22:23], v[42:43] op_sel_hi:[1,0,1]
  v_lshlrev_b32 v2, 16, v90
  v_and_b32 v3, 0xffff0000, v90
  v_pk_fma_f32 v[44:45], v[2:3], v[22:23], v[44:45] op_sel_hi:[1,0,1]
  v_lshlrev_b32 v4, 16, v91
  v_and_b32 v5, 0xffff0000, v91
  v_pk_fma_f32 v[46:47], v[4:5], v[22:23], v[46:47] op_sel_hi:[1,0,1]
  v_lshlrev_b32 v2, 16, v92
  v_and_b32 v3, 0xffff0000, v92
  v_pk_fma_f32 v[48:49], v[2:3], v[22:23], v[48:49] op_sel_hi:[1,0,1]
  v_lshlrev_b32 v4, 16, v93
  v_and_b32 v5, 0xffff0000, v93
  v_pk_fma_f32 v[50:51], v[4:5], v[22:23], v[50:51] op_sel_hi:[1,0,1]
  v_lshlrev_b32 v2, 16, v94
  v_and_b32 v3, 0xffff0000, v94
  v_pk_fma_f32 v[52:53], v[2:3], v[22:23], v[52:53] op_sel_hi:[1,0,1]
  v_lshlrev_b32 v4, 16, v95
  v_and_b32 v5, 0xffff0000, v95
  v_pk_fma_f32 v[54:55], v[4:5], v[22:23], v[54:55] op_sel_hi:[1,0,1]
  v_lshlrev_b32 v2, 16, v96
  v_and_b32 v3, 0xffff0000, v96
  v_pk_fma_f32 v[56:57], v[2:3], v[22:23], v[56:57] op_sel_hi:[1,0,1]
  v_lshlrev_b32 v4, 16, v97
  v_and_b32 v5, 0xffff0000, v97
  v_pk_fma_f32 v[58:59], v[4:5], v[22:23], v[58:59] op_sel_hi:[1,0,1]
  v_lshlrev_b32 v2, 16, v98
  v_and_b32 v3, 0xffff0000, v98
  v_pk_fma_f32 v[60:61], v[2:3], v[22:23], v[60:61] op_sel_hi:[1,0,1]
  v_lshlrev_b32 v4, 16, v99
  v_and_b32 v5, 0xffff0000, v99
  v_pk_fma_f32 v[62:63], v[4:5], v[22:23], v[62:63] op_sel_hi:[1,0,1]
  s_waitcnt vmcnt(12)
  v_lshlrev_b32 v2, 16, v100
  v_and_b32 v3, 0xffff0000, v100
  v_pk_fma_f32 v[40:41], v[2:3], v[22:23], v[40:41] op_sel:[0,1,0] op_sel_hi:[1,1,1]
  v_lshlrev_b32 v4, 16, v101
  v_and_b32 v5, 0xffff0000, v101
  v_pk_fma_f32 v[42:43], v[4:5], v[22:23], v[42:43] op_sel:[0,1,0] op_sel_hi:[1,1,1]
  v_lshlrev_b32 v2, 16, v102
  v_and_b32 v3, 0xffff0000, v102
  v_pk_fma_f32 v[44:45], v[2:3], v[22:23], v[44:45] op_sel:[0,1,0] op_sel_hi:[1,1,1]
  v_lshlrev_b32 v4, 16, v103
  v_and_b32 v5, 0xffff0000, v103
  v_pk_fma_f32 v[46:47], v[4:5], v[22:23], v[46:47] op_sel:[0,1,0] op_sel_hi:[1,1,1]
  v_lshlrev_b32 v2, 16, v104
  v_and_b32 v3, 0xffff0000, v104
  v_pk_fma_f32 v[48:49], v[2:3], v[22:23], v[48:49] op_sel:[0,1,0] op_sel_hi:[1,1,1]
  v_lshlrev_b32 v4, 16, v105
  v_and_b32 v5, 0xffff0000, v105
  v_pk_fma_f32 v[50:51], v[4:5], v[22:23], v[50:51] op_sel:[0,1,0] op_sel_hi:[1,1,1]
  v_lshlrev_b32 v2, 16, v106
  v_and_b32 v3, 0xffff0000, v106
  v_pk_fma_f32 v[52:53], v[2:3], v[22:23], v[52:53] op_sel:[0,1,0] op_sel_hi:[1,1,1]
  v_lshlrev_b32 v4, 16, v107
  v_and_b32 v5, 0xffff0000, v107
  v_pk_fma_f32 v[54:55], v[4:5], v[22:23], v[54:55] op_sel:[0,1,0] op_sel_hi:[1,1,1]
  v_lshlrev_b32 v2, 16, v108
  v_and_b32 v3, 0xffff0000, v108
  v_pk_fma_f32 v[56:57], v[2:3], v[22:23], v[56:57] op_sel:[0,1,0] op_sel_hi:[1,1,1]
  v_lshlrev_b32 v4, 16, v109
  v_and_b32 v5, 0xffff0000, v109
  v_pk_fma_f32 v[58:59], v[4:5], v[22:23], v[58:59] op_sel:[0,1,0] op_sel_hi:[1,1,1]
  v_lshlrev_b32 v2, 16, v110
  v_and_b32 v3, 0xffff0000, v110
  v_pk_fma_f32 v[60:61], v[2:3], v[22:23], v[60:61] op_sel:[0,1,0] op_sel_hi:[1,1,1]
  v_lshlrev_b32 v4, 16, v111
  v_and_b32 v5, 0xffff0000, v111
  v_pk_fma_f32 v[62:63], v[4:5], v[22:23], v[62:63] op_sel:[0,1,0] op_sel_hi:[1,1,1]
  s_waitcnt vmcnt(9)
  v_lshlrev_b32 v2, 16, v112
  v_and_b32 v3, 0xffff0000, v112
  v_pk_fma_f32 v[40:41], v[2:3], v[24:25], v[40:41] op_sel_hi:[1,0,1]
  v_lshlrev_b32 v4, 16, v113
  v_and_b32 v5, 0xffff0000, v113
  v_pk_fma_f32 v[42:43], v[4:5], v[24:25], v[42:43] op_sel_hi:[1,0,1]
  v_lshlrev_b32 v2, 16, v114
  v_and_b32 v3, 0xffff0000, v114
  v_pk_fma_f32 v[44:45], v[2:3], v[24:25], v[44:45] op_sel_hi:[1,0,1]
  v_lshlrev_b32 v4, 16, v115
  v_and_b32 v5, 0xffff0000, v115
  v_pk_fma_f32 v[46:47], v[4:5], v[24:25], v[46:47] op_sel_hi:[1,0,1]
  v_lshlrev_b32 v2, 16, v116
  v_and_b32 v3, 0xffff0000, v116
  v_pk_fma_f32 v[48:49], v[2:3], v[24:25], v[48:49] op_sel_hi:[1,0,1]
  v_lshlrev_b32 v4, 16, v117
  v_and_b32 v5, 0xffff0000, v117
  v_pk_fma_f32 v[50:51], v[4:5], v[24:25], v[50:51] op_sel_hi:[1,0,1]
  v_lshlrev_b32 v2, 16, v118
  v_and_b32 v3, 0xffff0000, v118
  v_pk_fma_f32 v[52:53], v[2:3], v[24:25], v[52:53] op_sel_hi:[1,0,1]
  v_lshlrev_b32 v4, 16, v119
  v_and_b32 v5, 0xffff0000, v119
  v_pk_fma_f32 v[54:55], v[4:5], v[24:25], v[54:55] op_sel_hi:[1,0,1]
  v_lshlrev_b32 v2, 16, v120
  v_and_b32 v3, 0xffff0000, v120
  v_pk_fma_f32 v[56:57], v[2:3], v[24:25], v[56:57] op_sel_hi:[1,0,1]
  v_lshlrev_b32 v4, 16, v121
  v_and_b32 v5, 0xffff0000, v121
  v_pk_fma_f32 v[58:59], v[4:5], v[24:25], v[58:59] op_sel_hi:[1,0,1]
  v_lshlrev_b32 v2, 16, v122
  v_and_b32 v3, 0xffff0000, v122
  v_pk_fma_f32 v[60:61], v[2:3], v[24:25], v[60:61] op_sel_hi:[1,0,1]
  v_lshlrev_b32 v4, 16, v123
  v_and_b32 v5, 0xffff0000, v123
  v_pk_fma_f32 v[62:63], v[4:5], v[24:25], v[62:63] op_sel_hi:[1,0,1]
  s_waitcnt vmcnt(6)
  v_lshlrev_b32 v2, 16, v124
  v_and_b32 v3, 0xffff0000, v124
  v_pk_fma_f32 v[40:41], v[2:3], v[24:25], v[40:41] op_sel:[0,1,0] op_sel_hi:[1,1,1]
  v_lshlrev_b32 v4, 16, v125
  v_and_b32 v5, 0xffff0000, v125
  v_pk_fma_f32 v[42:43], v[4:5], v[24:25], v[42:43] op_sel:[0,1,0] op_sel_hi:[1,1,1]
  v_lshlrev_b32 v2, 16, v126
  v_and_b32 v3, 0xffff0000, v126
  v_pk_fma_f32 v[44:45], v[2:3], v[24:25], v[44:45] op_sel:[0,1,0] op_sel_hi:[1,1,1]
  v_lshlrev_b32 v4, 16, v127
  v_and_b32 v5, 0xffff0000, v127
  v_pk_fma_f32 v[46:47], v[4:5], v[24:25], v[46:47] op_sel:[0,1,0] op_sel_hi:[1,1,1]
  v_lshlrev_b32 v2, 16, v128
  v_and_b32 v3, 0xffff0000, v128
  v_pk_fma_f32 v[48:49], v[2:3], v[24:25], v[48:49] op_sel:[0,1,0] op_sel_hi:[1,1,1]
  v_lshlrev_b32 v4, 16, v129
  v_and_b32 v5, 0xffff0000, v129
  v_pk_fma_f32 v[50:51], v[4:5], v[24:25], v[50:51] op_sel:[0,1,0] op_sel_hi:[1,1,1]
  v_lshlrev_b32 v2, 16, v130
  v_and_b32 v3, 0xffff0000, v130
  v_pk_fma_f32 v[52:53], v[2:3], v[24:25], v[52:53] op_sel:[0,1,0] op_sel_hi:[1,1,1]
  v_lshlrev_b32 v4, 16, v131
  v_and_b32 v5, 0xffff0000, v131
  v_pk_fma_f32 v[54:55], v[4:5], v[24:25], v[54:55] op_sel:[0,1,0] op_sel_hi:[1,1,1]
  v_lshlrev_b32 v2, 16, v132
  v_and_b32 v3, 0xffff0000, v132
  v_pk_fma_f32 v[56:57], v[2:3], v[24:25], v[56:57] op_sel:[0,1,0] op_sel_hi:[1,1,1]
  v_lshlrev_b32 v4, 16, v133
  v_and_b32 v5, 0xffff0000, v133
  v_pk_fma_f32 v[58:59], v[4:5], v[24:25], v[58:59] op_sel:[0,1,0] op_sel_hi:[1,1,1]
  v_lshlrev_b32 v2, 16, v134
  v_and_b32 v3, 0xffff0000, v134
  v_pk_fma_f32 v[60:61], v[2:3], v[24:25], v[60:61] op_sel:[0,1,0] op_sel_hi:[1,1,1]
  v_lshlrev_b32 v4, 16, v135
  v_and_b32 v5, 0xffff0000, v135
  v_pk_fma_f32 v[62:63], v[4:5], v[24:25], v[62:63] op_sel:[0,1,0] op_sel_hi:[1,1,1]
  s_waitcnt vmcnt(3)
  v_lshlrev_b32 v2, 16, v136
  v_and_b32 v3, 0xffff0000, v136
  v_pk_fma_f32 v[40:41], v[2:3], v[26:27], v[40:41] op_sel_hi:[1,0,1]
  v_lshlrev_b32 v4, 16, v137
  v_and_b32 v5, 0xffff0000, v137
  v_pk_fma_f32 v[42:43], v[4:5], v[26:27], v[42:43] op_sel_hi:[1,0,1]
  v_lshlrev_b32 v2, 16, v138
  v_and_b32 v3, 0xffff0000, v138
  v_pk_fma_f32 v[44:45], v[2:3], v[26:27], v[44:45] op_sel_hi:[1,0,1]
  v_lshlrev_b32 v4, 16, v139
  v_and_b32 v5, 0xffff0000, v139
  v_pk_fma_f32 v[46:47], v[4:5], v[26:27], v[46:47] op_sel_hi:[1,0,1]
  v_lshlrev_b32 v2, 16, v140
  v_and_b32 v3, 0xffff0000, v140
  v_pk_fma_f32 v[48:49], v[2:3], v[26:27], v[48:49] op_sel_hi:[1,0,1]
  v_lshlrev_b32 v4, 16, v141
  v_and_b32 v5, 0xffff0000, v141
  v_pk_fma_f32 v[50:51], v[4:5], v[26:27], v[50:51] op_sel_hi:[1,0,1]
  v_lshlrev_b32 v2, 16, v142
  v_and_b32 v3, 0xffff0000, v142
  v_pk_fma_f32 v[52:53], v[2:3], v[26:27], v[52:53] op_sel_hi:[1,0,1]
  v_lshlrev_b32 v4, 16, v143
  v_and_b32 v5, 0xffff0000, v143
  v_pk_fma_f32 v[54:55], v[4:5], v[26:27], v[54:55] op_sel_hi:[1,0,1]
  v_lshlrev_b32 v2, 16, v144
  v_and_b32 v3, 0xffff0000, v144
  v_pk_fma_f32 v[56:57], v[2:3], v[26:27], v[56:57] op_sel_hi:[1,0,1]
  v_lshlrev_b32 v4, 16, v145
  v_and_b32 v5, 0xffff0000, v145
  v_pk_fma_f32 v[58:59], v[4:5], v[26:27], v[58:59] op_sel_hi:[1,0,1]
  v_lshlrev_b32 v2, 16, v146
  v_and_b32 v3, 0xffff0000, v146
  v_pk_fma_f32 v[60:61], v[2:3], v[26:27], v[60:61] op_sel_hi:[1,0,1]
  v_lshlrev_b32 v4, 16, v147
  v_and_b32 v5, 0xffff0000, v147
  v_pk_fma_f32 v[62:63], v[4:5], v[26:27], v[62:63] op_sel_hi:[1,0,1]
  s_waitcnt vmcnt(0)
  v_lshlrev_b32 v2, 16, v148
  v_and_b32 v3, 0xffff0000, v148
  v_pk_fma_f32 v[40:41], v[2:3], v[26:27], v[40:41] op_sel:[0,1,0] op_sel_hi:[1,1,1]
  v_lshlrev_b32 v4, 16, v149
  v_and_b32 v5, 0xffff0000, v149
  v_pk_fma_f32 v[42:43], v[4:5], v[26:27], v[42:43] op_sel:[0,1,0] op_sel_hi:[1,1,1]
  v_lshlrev_b32 v2, 16, v150
  v_and_b32 v3, 0xffff0000, v150
  v_pk_fma_f32 v[44:45], v[2:3], v[26:27], v[44:45] op_sel:[0,1,0] op_sel_hi:[1,1,1]
  v_lshlrev_b32 v4, 16, v151
  v_and_b32 v5, 0xffff0000, v151
  v_pk_fma_f32 v[46:47], v[4:5], v[26:27], v[46:47] op_sel:[0,1,0] op_sel_hi:[1,1,1]
  v_lshlrev_b32 v2, 16, v152
  v_and_b32 v3, 0xffff0000, v152
  v_pk_fma_f32 v[48:49], v[2:3], v[26:27], v[48:49] op_sel:[0,1,0] op_sel_hi:[1,1,1]
  v_lshlrev_b32 v4, 16, v153
  v_and_b32 v5, 0xffff0000, v153
  v_pk_fma_f32 v[50:51], v[4:5], v[26:27], v[50:51] op_sel:[0,1,0] op_sel_hi:[1,1,1]
  v_lshlrev_b32 v2, 16, v154
  v_and_b32 v3, 0xffff0000, v154
  v_pk_fma_f32 v[52:53], v[2:3], v[26:27], v[52:53] op_sel:[0,1,0] op_sel_hi:[1,1,1]
  v_lshlrev_b32 v4, 16, v155
  v_and_b32 v5, 0xffff0000, v155
  v_pk_fma_f32 v[54:55], v[4:5], v[26:27], v[54:55] op_sel:[0,1,0] op_sel_hi:[1,1,1]
  v_lshlrev_b32 v2, 16, v156
  v_and_b32 v3, 0xffff0000, v156
  v_pk_fma_f32 v[56:57], v[2:3], v[26:27], v[56:57] op_sel:[0,1,0] op_sel_hi:[1,1,1]
  v_lshlrev_b32 v4, 16, v157
  v_and_b32 v5, 0xffff0000, v157
  v_pk_fma_f32 v[58:59], v[4:5], v[26:27], v[58:59] op_sel:[0,1,0] op_sel_hi:[1,1,1]
  v_lshlrev_b32 v2, 16, v158
  v_and_b32 v3, 0xffff0000, v158
  v_pk_fma_f32 v[60:61], v[2:3], v[26:27], v[60:61] op_sel:[0,1,0] op_sel_hi:[1,1,1]
  v_lshlrev_b32 v4, 16, v159
  v_and_b32 v5, 0xffff0000, v159
  v_pk_fma_f32 v[62:63], v[4:5], v[26:27], v[62:63] op_sel:[0,1,0] op_sel_hi:[1,1,1]
  v_add_f32_dpp v7, v7, v7 row_ror:8 row_mask:0xf bank_mask:0xf
  v_permlane32_swap_b32 v40, v44
  v_permlane32_swap_b32 v41, v45
  v_permlane32_swap_b32 v42, v46
  v_permlane32_swap_b32 v43, v47
  v_permlane32_swap_b32 v48, v52
  v_permlane32_swap_b32 v49, v53
  v_permlane32_swap_b32 v50, v54
  v_permlane32_swap_b32 v51, v55
  v_permlane32_swap_b32 v56, v60
  v_permlane32_swap_b32 v57, v61
  v_permlane32_swap_b32 v58, v62
  v_permlane32_swap_b32 v59, v63
  v_mov_b32 v3, v7
  v_add_f32 v40, v40, v44
  v_add_f32 v41, v41, v45
  v_add_f32 v42, v42, v46
  v_add_f32 v43, v43, v47
  v_add_f32 v48, v48, v52
  v_add_f32 v49, v49, v53
  v_add_f32 v50, v50, v54
  v_add_f32 v51, v51, v55
  v_add_f32 v56, v56, v60
  v_add_f32 v57, v57, v61
  v_add_f32 v58, v58, v62
  v_add_f32 v59, v59, v63
  v_permlane16_swap_b32 v7, v3
  v_permlane16_swap_b32 v40, v42
  v_permlane16_swap_b32 v41, v43
  v_permlane16_swap_b32 v48, v50
  v_permlane16_swap_b32 v49, v51
  v_permlane16_swap_b32 v56, v58
  v_permlane16_swap_b32 v57, v59
  v_add_f32 v7, v7, v3
  v_add_f32 v40, v40, v42
  v_add_f32 v41, v41, v43
  v_add_f32 v48, v48, v50
  v_add_f32 v49, v49, v51
  v_add_f32 v56, v56, v58
  v_add_f32 v57, v57, v59
  v_mov_b32 v3, v7
  v_add_f32_dpp v40, v40, v40 row_ror:8 row_mask:0xf bank_mask:0x3
  v_add_f32_dpp v48, v48, v48 row_ror:8 row_mask:0xf bank_mask:0x3
  v_add_f32_dpp v56, v56, v56 row_ror:8 row_mask:0xf bank_mask:0x3
  v_permlane32_swap_b32 v7, v3
  v_add_f32_dpp v40, v41, v41 row_ror:8 row_mask:0xf bank_mask:0xc
  v_add_f32_dpp v48, v49, v49 row_ror:8 row_mask:0xf bank_mask:0xc
  v_add_f32_dpp v56, v57, v57 row_ror:8 row_mask:0xf bank_mask:0xc
  v_add_f32 v7, v7, v3
  v_mov_b32 v5, s23
  ds_write_b32 v162, v40 offset:16384
  ds_write_b32 v162, v48 offset:16640
  ds_write_b32 v162, v56 offset:16896
  ds_write_b64 v5, v[6:7] offset:17152
  s_waitcnt lgkmcnt(0)
  s_barrier
  v_cmp_gt_u32 vcc, 96, v0
  s_and_saveexec_b64 s[22:23], vcc
  s_cbranch_execz L_end
  v_mov_b32 v1, 0
  v_lshlrev_b32 v4, 3, v0
  ds_read_b64 v[12:13], v1 offset:17152
  ds_read_b64 v[16:17], v1 offset:17936
  ds_read_b64 v[20:21], v1 offset:18720
  ds_read_b64 v[24:25], v1 offset:19504
  ds_read_b64 v[14:15], v4 offset:16384
  ds_read_b64 v[18:19], v4 offset:17168
  ds_read_b64 v[22:23], v4 offset:17952
  ds_read_b64 v[26:27], v4 offset:18736
  s_mul_i32 s22, s2, 384
  s_add_u32 s12, s30, s22
  s_addc_u32 s13, s31, 0
  s_and_b32 s13, s13, 0xffff
  v_lshlrev_b32 v4, 2, v0
  s_waitcnt lgkmcnt(4)
  v_mov_b32 v2, v12
  v_max_f32 v2, v2, v16
  v_max_f32 v2, v2, v20
  v_max_f32 v2, v2, v24
  v_sub_f32 v12, v12, v2
  v_sub_f32 v16, v16, v2
  v_sub_f32 v20, v20, v2
  v_sub_f32 v24, v24, v2
  v_mul_f32 v12, s19, v12
  v_mul_f32 v16, s19, v16
  v_mul_f32 v20, s19, v20
  v_mul_f32 v24, s19, v24
  v_exp_f32 v12, v12
  v_exp_f32 v16, v16
  v_exp_f32 v20, v20
  v_exp_f32 v24, v24
  s_waitcnt lgkmcnt(0)
  v_mul_f32 v6, v12, v13
  v_mul_f32 v8, v12, v14
  v_mul_f32 v9, v12, v15
  v_fma_f32 v6, v16, v17, v6
  v_fma_f32 v8, v16, v18, v8
  v_fma_f32 v9, v16, v19, v9
  v_fma_f32 v6, v20, v21, v6
  v_fma_f32 v8, v20, v22, v8
  v_fma_f32 v9, v20, v23, v9
  v_fma_f32 v6, v24, v25, v6
  v_fma_f32 v8, v24, v26, v8
  v_fma_f32 v9, v24, v27, v9
  v_rcp_f32 v6, v6
  s_nop 0
  v_mul_f32 v8, v8, v6
  v_mul_f32 v9, v9, v6
  v_cvt_pk_bf16_f32 v8, v8, v9
  buffer_store_dword v8, v4, s[12:15], 0 offen
L_end:
  s_endpgm
L_help:
  s_mul_i32 s57, s2, 4096
  v_mov_b32 v163, s57
  v_and_b32 v10, 7, v3
  v_lshlrev_b32 v9, 2, v10
  v_mul_u32_u24 v10, 4096, v10
  v_mov_b32 v11, 0
  ds_write_b32 v11, v11 offset:20000
  s_mov_b64 exec, 1
  global_store_dword v11, v11, s[50:51]
  s_cmp_ge_u32 s2, 8
  s_cbranch_scc1 L_hi
  global_store_dword v163, v11, s[48:49] sc1
L_hi:
  s_mov_b64 exec, -1
  s_and_b32 s58, s2, 4294967292
  s_mov_b32 s59, 4000
  s_waitcnt vmcnt(0) lgkmcnt(0)
  s_barrier
  s_cmp_ge_u32 s2, 8
  s_cbranch_scc1 L_end
  s_lshl_b32 s57, s2, 2
  v_mov_b32 v7, s57
  v_mov_b32 v6, 1
  s_mov_b64 exec, 1
  global_store_dword v7, v6, s[62:63] sc1
  s_mov_b64 exec, -1
L_hw:
  ds_read_b32 v164, v11 offset:20000
  global_load_dword v8, v9, s[62:63] sc1
  s_waitcnt vmcnt(0) lgkmcnt(0)
  v_readfirstlane_b32 s57, v164
  s_nop 1
  v_add_u32_dpp v8, v8, v8 quad_perm:[1,0,3,2] row_mask:0xf bank_mask:0xf
  s_nop 1
  v_add_u32_dpp v8, v8, v8 quad_perm:[2,3,0,1] row_mask:0xf bank_mask:0xf
  s_nop 1
  v_add_u32_dpp v8, v8, v8 row_half_mirror row_mask:0xf bank_mask:0xf
  s_nop 0
  v_readfirstlane_b32 s60, v8
  s_cmp_eq_u32 s60, 8
  s_cbranch_scc1 L_hl
  s_sub_u32 s59, s59, 1
  s_cmp_eq_u32 s59, 0
  s_cbranch_scc1 L_end
  s_cmp_lt_u32 s57, 30
  s_cbranch_scc1 L_hw
  s_endpgm
L_hl:
  ds_read_b32 v164, v11 offset:20000
  global_load_dword v8, v10, s[48:49] sc1
  s_waitcnt lgkmcnt(0)
  v_readfirstlane_b32 s57, v164
  s_add_u32 s60, s57, s2
  s_and_b32 s60, s60, 4294967292
  s_cmp_eq_u32 s60, s58
  s_cbranch_scc1 L_hn
  s_mov_b32 s58, s60
  s_mov_b64 exec, 1
  global_store_dword v163, v164, s[48:49] sc1
  s_mov_b64 exec, -1
  s_waitcnt vmcnt(1)
  s_branch L_hs
L_hn:
  s_waitcnt vmcnt(0)
L_hs:
  s_nop 1
  v_add_u32_dpp v8, v8, v8 quad_perm:[1,0,3,2] row_mask:0xf bank_mask:0xf
  s_nop 1
  v_add_u32_dpp v8, v8, v8 quad_perm:[2,3,0,1] row_mask:0xf bank_mask:0xf
  s_nop 1
  v_add_u32_dpp v8, v8, v8 row_half_mirror row_mask:0xf bank_mask:0xf
  s_mov_b64 exec, 1
  global_store_dword v11, v8, s[50:51]
  s_mov_b64 exec, -1
  s_waitcnt vmcnt(0)
  s_sub_u32 s59, s59, 1
  s_cmp_eq_u32 s59, 0
  s_cbranch_scc1 L_end
  s_cmp_lt_u32 s57, 30
  s_cbranch_scc1 L_hl
  s_endpgm
.section .rodata,"a"
.p2align 6
.amdhsa_kernel standalone__softmax_full_bidir__sampling_kernel
  .amdhsa_next_free_vgpr 168
  .amdhsa_next_free_sgpr 64
  .amdhsa_accum_offset 168
  .amdhsa_group_segment_fixed_size 0
  .amdhsa_kernarg_size 48
  .amdhsa_user_sgpr_count 2
  .amdhsa_user_sgpr_kernarg_segment_ptr 1
  .amdhsa_system_sgpr_workgroup_id_x 1
.end_amdhsa_kernel
```
